```python
import torch

def _softmax(x, axis=-1):
    return torch.softmax(x, dim=axis)
def _gelu(x):
    return torch.nn.functional.gelu(x, approximate="tanh")
def _silu(x):
    return torch.nn.functional.silu(x)
def _sigmoid(x):
    return torch.sigmoid(x)
def _layernorm(x, axis=-1, eps=1e-5):
    m = x.mean(dim=axis, keepdim=True)
    v = x.var(dim=axis, keepdim=True, unbiased=False)
    return (x - m) / torch.sqrt(v + eps)
def _scatter_add(tgt, idx, src, axis=0):
    return tgt.clone().index_add_(axis, idx, src)
def _segment_sum(src, seg, n):
    out = torch.zeros((n,) + src.shape[1:], dtype=src.dtype)
    return out.index_add_(0, seg, src)
def _pad(x, pw):
    flat = tuple(v for pair in reversed(pw) for v in pair)
    return torch.nn.functional.pad(x, flat)

kernel_name = 'recurrent_scan__ssm_conv_h3__mixer_channel_mlp__prompt'

def setup_inputs():

    _w = (lambda a: (lambda t: t.to(torch.bfloat16) if t.is_floating_point() else t)(torch.as_tensor(a)))
    def _A_setup():
        B, S, D = 1, 2048, 512
        ks = 4
        return {
            "q": _w((lambda *s: torch.randn(*s, dtype=torch.bfloat16) * 0.05)(B, S, D)),
            "k": _w((lambda *s: torch.randn(*s, dtype=torch.bfloat16) * 0.8)(B, S, D)),
            "v": _w((lambda *s: torch.randn(*s, dtype=torch.bfloat16) * 0.8)(B, S, D)),
            "shift_k": _w((lambda *s: torch.randn(*s, dtype=torch.bfloat16) * 0.8)(D, ks) * 0.5),
            "ssm_k": _w((lambda *s: torch.randn(*s, dtype=torch.bfloat16) * 0.8)(D, S) * (1.0 / S ** 0.5)),
            "ssm_D": _w((lambda *s: torch.randn(*s, dtype=torch.bfloat16) * 0.8)(D)),
        }
    _A_in = _A_setup()

    def _B_setup():
        B, S, D, F = 1, 2048, 512, 1376
        return {
            "x": _w((lambda *s: torch.randn(*s, dtype=torch.bfloat16) * 0.05)(B, S, D)),
            "w1": _w((lambda *s: torch.randn(*s, dtype=torch.bfloat16) * 0.8)(D, F) * (D ** -0.5)),
            "b1": _w((lambda *s: torch.randn(*s, dtype=torch.bfloat16) * 0.4)(F)),
            "w2": _w((lambda *s: torch.randn(*s, dtype=torch.bfloat16) * 0.2)(F, D) * (F ** -0.5)),
            "b2": _w((lambda *s: torch.randn(*s, dtype=torch.bfloat16) * 0.2)(D)),
        }
    _B_in = _B_setup()

    return {
        "A_q": _A_in["q"],
        "A_k": _A_in["k"],
        "A_v": _A_in["v"],
        "A_shift_k": _A_in["shift_k"],
        "A_ssm_k": _A_in["ssm_k"],
        "A_ssm_D": _A_in["ssm_D"],
        "B_x": _B_in["x"],
        "B_w1": _B_in["w1"],
        "B_b1": _B_in["b1"],
        "B_w2": _B_in["w2"],
        "B_b2": _B_in["b2"],
    }

def reference(A_q, A_k, A_v, A_shift_k, A_ssm_k, A_ssm_D, B_x, B_w1, B_b1, B_w2, B_b2):
    def _A_ref(q, k, v, shift_k, ssm_k, ssm_D):
        B, S, D = q.shape
        ks = shift_k.shape[-1]
        k_pad = _pad(k, ((0, 0), (ks - 1, 0), (0, 0)))
        k_shift = torch.zeros_like(k)
        for t in range(ks):
            k_shift = k_shift + k_pad[:, t:t + S, :] * shift_k[:, ks - 1 - t][None, None, :]
        kv = k_shift * v
        L = 2 * S
        kv_pad = _pad(kv, ((0, 0), (0, S), (0, 0)))
        kf_pad = _pad(ssm_k, ((0, 0), (0, S)))
        kv_f = (lambda x, axes=(-2,-1): torch.fft.rfft2(x.float(), dim=axes))(kv_pad[:, None, :, :], axes=(1, 2))
        kf_f = (lambda x, axes=(-2,-1): torch.fft.rfft2(x.float(), dim=axes))(kf_pad[:, None, :], axes=(1, 2))
        kf_f = (lambda x, *d: x.permute(*d))(kf_f, 1, 2, 0)
        y_f = kv_f * kf_f[None, :, :, :]
        y = (lambda x, s, axes=(-2,-1): torch.fft.irfft2(x, s=s, dim=axes).to(torch.bfloat16))(y_f, (1, L), axes=(1, 2))[:, 0, :S, :]
        y = y + kv * ssm_D[None, None, :]
        return q * y

    def _B_ref(x, w1, b1, w2, b2):
        y = _layernorm(x, axis=-1)
        h = _gelu(torch.einsum("bsd,df->bsf", y, w1) + b1)
        return torch.einsum("bsf,fd->bsd", h, w2) + b2

    x = A_q
    xn = _layernorm(x, axis=-1)
    s = _A_ref(xn, A_k, A_v, A_shift_k, A_ssm_k, A_ssm_D)
    g = _silu(_B_ref(xn, B_w1, B_b1, B_w2, B_b2))
    return x + s * g
```

```asm
; @launch grid=(256,1,1) block=(640,1,1) lds=163840
.amdgcn_target "amdgcn-amd-amdhsa--gfx950"
.text
.globl recurrent_scan__ssm_conv_h3__mixer_channel_mlp__prompt_kernel
.p2align 8
.type recurrent_scan__ssm_conv_h3__mixer_channel_mlp__prompt_kernel,@function
recurrent_scan__ssm_conv_h3__mixer_channel_mlp__prompt_kernel:
    s_load_dwordx4 s[8:11], s[0:1], 0
    s_load_dwordx4 s[16:19], s[0:1], 16
    s_load_dwordx4 s[32:35], s[0:1], 56
    s_load_dwordx2 s[52:53], s[0:1], 104
    s_load_dwordx4 s[24:27], s[0:1], 32
    s_load_dwordx4 s[40:43], s[0:1], 72
    s_load_dwordx2 s[48:49], s[0:1], 88
    s_cmp_ge_u32 s2, 256
    s_cbranch_scc1 L_end
    s_getpc_b64 s[100:101]
L_pc0:
    s_lshr_b32 s4, s2, 3
    s_mul_i32 s7, s4, 9
    v_add_u32 v3, s7, v0
    v_lshlrev_b32 v3, 7, v3
    v_min_u32 v3, 35200, v3
    v_cmp_gt_u32 vcc, 9, v0
    s_and_b64 exec, exec, vcc
    s_cbranch_execz L_nopf
    global_load_dword v167, v3, s[100:101]
L_nopf:
    s_mov_b64 exec, -1
    v_readfirstlane_b32 s62, v0
    v_and_b32 v1, 63, v0
    v_lshlrev_b32 v2, 4, v1
    v_lshlrev_b32 v3, 2, v1
    v_mov_b32_e64 v12, 0
    v_add_u32 v3, 160256, v3
    ds_write_b32 v3, v12
    s_and_b32 s3, s2, 7
    s_lshr_b32 s5, s4, 3
    s_and_b32 s59, s4, 7
    s_lshr_b32 s62, s62, 6
    s_lshl_b32 s58, s3, 2
    s_add_u32 s58, s58, s5
    s_lshr_b32 s6, s3, 1
    s_lshl_b32 s60, s6, 2
    s_add_u32 s60, s60, s5
    s_and_b32 s7, s3, 1
    s_mul_i32 s64, s7, 5
    s_add_u32 s64, s64, s59
    s_cmp_gt_u32 s59, 3
    s_subb_u32 s64, s64, 0
    s_lshr_b32 s61, s5, 1
    s_cmp_eq_u32 s61, s7
    s_cselect_b32 s69, 0, 2
    s_cmp_eq_u32 s59, 6
    s_cselect_b32 s69, s69, 0
    s_cselect_b32 s64, 10, s64
    s_and_b32 s61, s59, 3
    s_cmp_eq_u32 s61, 3
    s_cselect_b32 s69, 1, s69
    s_lshl_b32 s61, s64, 2
    s_cmp_lt_u32 s62, 2
    s_cbranch_scc1 L_loader
    s_sub_u32 s62, s62, 2
    v_subrev_u32 v0, 128, v0
    s_and_b32 s65, s62, 3
    s_lshr_b32 s66, s62, 2
    s_mov_b32 s63, 0xffff0000
    s_lshl_b32 s70, s58, 6
    s_lshl_b32 s4, s59, 3
    s_add_u32 s70, s70, s4
    s_add_u32 s70, s70, s62
    s_lshl_b32 s6, s70, 10
    s_and_b32 s71, s58, 0x1e
    s_and_b32 s72, s5, 1
    s_lshl_b32 s72, s72, 2
    s_lshr_b32 s4, s59, 2
    s_lshl_b32 s4, s4, 1
    s_add_u32 s72, s72, s4
    s_add_u32 s72, s72, s66
    s_lshl_b32 s3, s71, 16
    s_lshl_b32 s4, s65, 14
    s_add_u32 s3, s3, s4
    s_lshl_b32 s4, s72, 7
    s_add_u32 s3, s3, s4
    v_lshrrev_b32 v21, 5, v1
    v_lshlrev_b32 v21, 13, v21
    v_and_b32_e64 v24, 31, v1
    v_lshl_add_u32 v21, v24, 2, v21
    v_add_u32_e64 v21, s3, v21
    v_add_u32 v22, 0xfffff400, v21
    v_add_u32 v23, 0x1000, v21
    v_lshlrev_b32 v24, 4, v24
    s_lshl_b32 s5, s72, 9
    v_lshlrev_b32 v3, 1, v0
    s_lshl_b32 s3, s61, 6
    s_mov_b32 s14, 0x200000
    s_mov_b32 s15, 0x20000
    s_mov_b32 s22, 4096
    s_mov_b32 s23, 0x20000
    s_mov_b32 s38, 2752
    s_mov_b32 s39, 0x20000
    s_mov_b32 s7, 0x10000
    s_waitcnt lgkmcnt(0)
    s_mov_b64 s[12:13], s[10:11]
    s_mov_b64 s[20:21], s[18:19]
    s_mov_b64 s[36:37], s[34:35]
    s_mov_b32 s10, 0x200000
    s_mov_b32 s11, 0x20000
    s_mov_b32 s18, 0x200000
    s_mov_b32 s19, 0x20000
    buffer_load_dwordx4 v[14:17], v2, s[8:11], s6 offen
    buffer_load_ushort v18, v3, s[36:39], s3 offen
    s_barrier
    s_lshl_b32 s4, s59, 7
    s_lshl_b32 s6, s58, 2
    s_add_u32 s4, s4, s6
    s_load_dword s56, s[52:53], 0
    s_load_dword s73, s[26:27], s4
    s_mov_b32 s30, s5
    s_mov_b32 s31, 0x10000
    s_lshl_b32 s3, s66, 2
    s_or_b32 s29, s3, s69
    s_cmp_lg_u32 s29, 1
    s_cbranch_scc1 L_nokv
    s_nop 0
    buffer_load_dwordx4 v[26:29], v24, s[20:23], s30 offen
    buffer_load_dword v30, v22, s[12:15], 0 offen offset:0
    buffer_load_dword v31, v22, s[12:15], 0 offen offset:1024
    buffer_load_dword v32, v22, s[12:15], 0 offen offset:2048
    buffer_load_dword v33, v21, s[12:15], 0 offen offset:0
    buffer_load_dword v34, v21, s[12:15], 0 offen offset:1024
    buffer_load_dword v35, v21, s[12:15], 0 offen offset:2048
    buffer_load_dword v36, v21, s[12:15], 0 offen offset:3072
    buffer_load_dword v37, v23, s[12:15], 0 offen offset:0
    buffer_load_dword v38, v23, s[12:15], 0 offen offset:1024
    buffer_load_dword v39, v23, s[12:15], 0 offen offset:2048
    buffer_load_dword v40, v23, s[12:15], 0 offen offset:3072
    buffer_load_dword v54, v21, s[16:19], 0 offen offset:0
    buffer_load_dword v55, v21, s[16:19], 0 offen offset:1024
    buffer_load_dword v56, v21, s[16:19], 0 offen offset:2048
    buffer_load_dword v57, v21, s[16:19], 0 offen offset:3072
    buffer_load_dword v58, v23, s[16:19], 0 offen offset:0
    buffer_load_dword v59, v23, s[16:19], 0 offen offset:1024
    buffer_load_dword v60, v23, s[16:19], 0 offen offset:2048
    buffer_load_dword v61, v23, s[16:19], 0 offen offset:3072
    v_add_u32 v22, 0x10000, v22
    buffer_load_dword v42, v22, s[12:15], 0 offen offset:0
    buffer_load_dword v43, v22, s[12:15], 0 offen offset:1024
    buffer_load_dword v44, v22, s[12:15], 0 offen offset:2048
    buffer_load_dword v45, v21, s[12:15], s31 offen offset:0
    buffer_load_dword v46, v21, s[12:15], s31 offen offset:1024
    buffer_load_dword v47, v21, s[12:15], s31 offen offset:2048
    buffer_load_dword v48, v21, s[12:15], s31 offen offset:3072
    buffer_load_dword v49, v23, s[12:15], s31 offen offset:0
    buffer_load_dword v50, v23, s[12:15], s31 offen offset:1024
    buffer_load_dword v51, v23, s[12:15], s31 offen offset:2048
    buffer_load_dword v52, v23, s[12:15], s31 offen offset:3072
    buffer_load_dword v62, v21, s[16:19], s31 offen offset:0
    buffer_load_dword v63, v21, s[16:19], s31 offen offset:1024
    buffer_load_dword v64, v21, s[16:19], s31 offen offset:2048
    buffer_load_dword v65, v21, s[16:19], s31 offen offset:3072
    buffer_load_dword v66, v23, s[16:19], s31 offen offset:0
    buffer_load_dword v67, v23, s[16:19], s31 offen offset:1024
    buffer_load_dword v68, v23, s[16:19], s31 offen offset:2048
    buffer_load_dword v69, v23, s[16:19], s31 offen offset:3072
L_nokv:
    s_mov_b64 s[44:45], s[42:43]
    s_nop 0
    s_mov_b32 s46, 1024
    s_mov_b32 s47, 0x20000
    s_mov_b32 s50, 0x200000
    s_mov_b32 s51, 0x20000
    s_mov_b32 s54, 10878976
    s_mov_b32 s55, 0x20000
    v_cmp_eq_u32 vcc, 63, v1
    v_mov_b32 v4, 0xffffff00
    s_nop 0
    v_cndmask_b32_e64 v4, v4, 0, vcc
    v_mov_b32 v6, 160256
    s_lshl_b32 s3, s65, 2
    v_add_u32 v7, s3, v6
    s_cmp_eq_u32 s66, 0
    s_cselect_b32 s67, 24, 19
    s_and_b32 s3, s58, 3
    s_lshl_b32 s3, s3, 1
    s_add_u32 s3, s3, s59
    s_and_b32 s3, s3, 7
    s_mul_i32 s68, s3, s67
    s_lshr_b32 s68, s68, 3
    s_lshr_b32 s3, s58, 2
    s_add_u32 s68, s68, s3
    s_cmp_ge_u32 s68, s67
    s_cselect_b32 s3, s67, 0
    s_sub_u32 s68, s68, s3
    s_sub_u32 s67, s67, s68
    s_lshl_b32 s3, s66, 4
    v_add_u32 v19, s3, v7
    v_add_u32 v20, s3, v6
    s_waitcnt lgkmcnt(0)
    s_add_u32 s56, s56, 0x9e3779b9
    s_mov_b32 s57, s56
    v_mov_b32 v5, s56
    v_mov_b32_e64 v12, 1
    ds_write_b32 v19, v12 offset:208
    s_cmp_eq_u32 s29, 1
    s_cbranch_scc1 L_p0
    s_waitcnt vmcnt(0)
    v_lshlrev_b32 v18, 16, v18
    v_min_u32 v25, 128, v0
    v_lshlrev_b32_e64 v25, 2, v25
    v_add_u32 v25, 161024, v25
    v_mov_b32 v41, 0x3f803f80
    ds_write_b32 v25, v18
    v_lshlrev_b32 v74, 16, v14
    v_and_b32 v75, s63, v14
    v_lshlrev_b32 v76, 16, v15
    v_and_b32 v77, s63, v15
    v_lshlrev_b32 v78, 16, v16
    v_and_b32 v79, s63, v16
    v_lshlrev_b32 v80, 16, v17
    v_and_b32 v81, s63, v17
    v_pk_add_f32 v[90:91], v[74:75], v[76:77]
    v_pk_add_f32 v[92:93], v[78:79], v[80:81]
    s_nop 0
    v_pk_add_f32 v[90:91], v[90:91], v[92:93]
    s_nop 0
    v_add_f32 v90, v90, v91
    s_nop 1
    v_add_f32_dpp v90, v90, v90 row_shr:1 row_mask:0xf bank_mask:0xf bound_ctrl:0
    s_nop 1
    v_add_f32_dpp v90, v90, v90 row_shr:2 row_mask:0xf bank_mask:0xf bound_ctrl:0
    s_nop 1
    v_add_f32_dpp v90, v90, v90 row_shr:4 row_mask:0xf bank_mask:0xf bound_ctrl:0
    s_nop 1
    v_add_f32_dpp v90, v90, v90 row_shr:8 row_mask:0xf bank_mask:0xf bound_ctrl:0
    s_nop 1
    v_add_f32_dpp v90, v90, v90 row_bcast:15 row_mask:0xa bank_mask:0xf
    s_nop 1
    v_add_f32_dpp v90, v90, v90 row_bcast:31 row_mask:0xc bank_mask:0xf
    v_mul_f32 v90, 0x3b000000, v90
    s_nop 0
    v_readlane_b32 s32, v90, 63
    v_readlane_b32 s33, v90, 63
    s_nop 1
    s_nop 0
    v_pk_add_f32 v[82:83], v[74:75], s[32:33] neg_lo:[0,1] neg_hi:[0,1]
    v_pk_add_f32 v[84:85], v[76:77], s[32:33] neg_lo:[0,1] neg_hi:[0,1]
    v_pk_add_f32 v[86:87], v[78:79], s[32:33] neg_lo:[0,1] neg_hi:[0,1]
    v_pk_add_f32 v[88:89], v[80:81], s[32:33] neg_lo:[0,1] neg_hi:[0,1]
    v_pk_mul_f32 v[92:93], v[82:83], v[82:83]
    s_nop 0
    v_pk_fma_f32 v[92:93], v[84:85], v[84:85], v[92:93]
    s_nop 0
    v_pk_fma_f32 v[92:93], v[86:87], v[86:87], v[92:93]
    s_nop 0
    v_pk_fma_f32 v[92:93], v[88:89], v[88:89], v[92:93]
    s_nop 0
    v_add_f32 v92, v92, v93
    s_nop 1
    v_add_f32_dpp v92, v92, v92 row_shr:1 row_mask:0xf bank_mask:0xf bound_ctrl:0
    s_nop 1
    v_add_f32_dpp v92, v92, v92 row_shr:2 row_mask:0xf bank_mask:0xf bound_ctrl:0
    s_nop 1
    v_add_f32_dpp v92, v92, v92 row_shr:4 row_mask:0xf bank_mask:0xf bound_ctrl:0
    s_nop 1
    v_add_f32_dpp v92, v92, v92 row_shr:8 row_mask:0xf bank_mask:0xf bound_ctrl:0
    s_nop 1
    v_add_f32_dpp v92, v92, v92 row_bcast:15 row_mask:0xa bank_mask:0xf
    s_nop 1
    s_nop 0
    v_add_f32_dpp v92, v92, v92 row_bcast:31 row_mask:0xc bank_mask:0xf
    v_mul_f32 v91, 0x3b000000, v92
    v_cvt_pk_bf16_f32 v25, v90, v91
    v_lshlrev_b32 v90, 16, v25
    v_and_b32 v91, s63, v25
    v_add_f32 v91, 0x3727c5ac, v91
    v_cvt_pk_bf16_f32 v25, v90, v91
    v_lshlrev_b32 v90, 16, v25
    v_and_b32 v91, s63, v25
    v_sqrt_f32 v91, v91
    s_nop 0
    v_cvt_pk_bf16_f32 v70, v90, v91
    v_and_b32 v91, s63, v70
    v_rcp_f32 v91, v91
    v_readlane_b32 s32, v90, 63
    v_readlane_b32 s33, v90, 63
    v_readlane_b32 s34, v91, 63
    v_readlane_b32 s35, v91, 63
    v_pk_add_f32 v[82:83], v[74:75], s[32:33] neg_lo:[0,1] neg_hi:[0,1]
    v_pk_add_f32 v[84:85], v[76:77], s[32:33] neg_lo:[0,1] neg_hi:[0,1]
    v_pk_add_f32 v[86:87], v[78:79], s[32:33] neg_lo:[0,1] neg_hi:[0,1]
    v_pk_add_f32 v[88:89], v[80:81], s[32:33] neg_lo:[0,1] neg_hi:[0,1]
    v_cvt_pk_bf16_f32 v25, v82, v83
    v_lshlrev_b32 v82, 16, v25
    v_and_b32 v83, s63, v25
    v_cvt_pk_bf16_f32 v25, v84, v85
    v_lshlrev_b32 v84, 16, v25
    v_and_b32 v85, s63, v25
    v_cvt_pk_bf16_f32 v25, v86, v87
    v_lshlrev_b32 v86, 16, v25
    v_and_b32 v87, s63, v25
    v_cvt_pk_bf16_f32 v25, v88, v89
    v_lshlrev_b32 v88, 16, v25
    v_and_b32 v89, s63, v25
    v_pk_mul_f32 v[82:83], v[82:83], s[34:35]
    v_pk_mul_f32 v[84:85], v[84:85], s[34:35]
    v_pk_mul_f32 v[86:87], v[86:87], s[34:35]
    v_pk_mul_f32 v[88:89], v[88:89], s[34:35]
    v_cvt_pk_bf16_f32 v74, v82, v83
    v_cvt_pk_bf16_f32 v75, v84, v85
    v_cvt_pk_bf16_f32 v76, v86, v87
    v_cvt_pk_bf16_f32 v77, v88, v89
    v_mov_b32 v90, 0
    v_mov_b32_e64 v91, 0
    v_dot2c_f32_bf16 v90, v74, v41
    v_dot2c_f32_bf16 v91, v74, v74
    v_dot2c_f32_bf16 v90, v75, v41
    v_dot2c_f32_bf16 v91, v75, v75
    v_dot2c_f32_bf16 v90, v76, v41
    v_dot2c_f32_bf16 v91, v76, v76
    v_dot2c_f32_bf16 v90, v77, v41
    v_dot2c_f32_bf16 v91, v77, v77
    s_nop 1
    v_add_f32_dpp v90, v90, v90 row_shr:1 row_mask:0xf bank_mask:0xf bound_ctrl:0
    v_add_f32_dpp v91, v91, v91 row_shr:1 row_mask:0xf bank_mask:0xf bound_ctrl:0
    s_nop 0
    v_add_f32_dpp v90, v90, v90 row_shr:2 row_mask:0xf bank_mask:0xf bound_ctrl:0
    v_add_f32_dpp v91, v91, v91 row_shr:2 row_mask:0xf bank_mask:0xf bound_ctrl:0
    s_nop 0
    v_add_f32_dpp v90, v90, v90 row_shr:4 row_mask:0xf bank_mask:0xf bound_ctrl:0
    v_add_f32_dpp v91, v91, v91 row_shr:4 row_mask:0xf bank_mask:0xf bound_ctrl:0
    s_nop 0
    v_add_f32_dpp v90, v90, v90 row_shr:8 row_mask:0xf bank_mask:0xf bound_ctrl:0
    v_add_f32_dpp v91, v91, v91 row_shr:8 row_mask:0xf bank_mask:0xf bound_ctrl:0
    s_nop 0
    v_add_f32_dpp v90, v90, v90 row_bcast:15 row_mask:0xa bank_mask:0xf
    v_add_f32_dpp v91, v91, v91 row_bcast:15 row_mask:0xa bank_mask:0xf
    s_nop 0
    s_nop 0
    v_add_f32_dpp v90, v90, v90 row_bcast:31 row_mask:0xc bank_mask:0xf
    v_add_f32_dpp v91, v91, v91 row_bcast:31 row_mask:0xc bank_mask:0xf
    v_mul_f32 v90, 0x3b000000, v90
    v_mul_f32 v91, 0x3b000000, v91
    v_fma_f32 v91, -v90, v90, v91
    v_max_f32_e64 v91, 0, v91
    v_cvt_pk_bf16_f32 v25, v90, v91
    v_lshlrev_b32 v90, 16, v25
    v_and_b32 v91, s63, v25
    v_add_f32 v91, 0x3727c5ac, v91
    v_cvt_pk_bf16_f32 v25, v90, v91
    v_lshlrev_b32 v90, 16, v25
    v_and_b32 v91, s63, v25
    v_sqrt_f32 v91, v91
    s_nop 0
    v_cvt_pk_bf16_f32 v71, v90, v91
    s_cmp_lg_u32 s62, 7
    s_cbranch_scc1 L_noepw0
    ds_read_b128 v[8:11], v6 offset:208
    s_waitcnt lgkmcnt(0)
    v_min3_u32 v8, v8, v9, v10
    v_min_u32 v8, v8, v11
    v_cmp_gt_u32 vcc, 1, v8
    s_cbranch_vccnz L_fs_1
L_fr_2:
    ds_read_b128 v[8:11], v6 offset:224
    s_waitcnt lgkmcnt(0)
    v_min3_u32 v8, v8, v9, v10
    v_min_u32 v8, v8, v11
    v_cmp_gt_u32 vcc, 1, v8
    s_cbranch_vccnz L_fs_4
L_fr_5:
    ds_read_b32 v8, v6 offset:196
    s_waitcnt lgkmcnt(0)
    v_cmp_gt_u32 vcc, 1, v8
    s_cbranch_vccnz L_fs_7
L_fr_8:
L_noepw0:
    s_lshl_b32 s3, s70, 4
    s_add_u32 s3, s3, 65536
    v_mov_b32 v72, s56
    v_mov_b32 v73, s56
    buffer_store_dwordx4 v[70:73], v4, s[52:55], s3 offen sc1
    s_cmp_lg_u32 s69, 1
    s_cbranch_scc1 L_cend
    buffer_load_dwordx4 v[26:29], v24, s[20:23], s30 offen
    buffer_load_dword v30, v22, s[12:15], 0 offen offset:0
    buffer_load_dword v31, v22, s[12:15], 0 offen offset:1024
    buffer_load_dword v32, v22, s[12:15], 0 offen offset:2048
    buffer_load_dword v33, v21, s[12:15], 0 offen offset:0
    buffer_load_dword v34, v21, s[12:15], 0 offen offset:1024
    buffer_load_dword v35, v21, s[12:15], 0 offen offset:2048
    buffer_load_dword v36, v21, s[12:15], 0 offen offset:3072
    buffer_load_dword v37, v23, s[12:15], 0 offen offset:0
    buffer_load_dword v38, v23, s[12:15], 0 offen offset:1024
    buffer_load_dword v39, v23, s[12:15], 0 offen offset:2048
    buffer_load_dword v40, v23, s[12:15], 0 offen offset:3072
    buffer_load_dword v54, v21, s[16:19], 0 offen offset:0
    buffer_load_dword v55, v21, s[16:19], 0 offen offset:1024
    buffer_load_dword v56, v21, s[16:19], 0 offen offset:2048
    buffer_load_dword v57, v21, s[16:19], 0 offen offset:3072
    buffer_load_dword v58, v23, s[16:19], 0 offen offset:0
    buffer_load_dword v59, v23, s[16:19], 0 offen offset:1024
    buffer_load_dword v60, v23, s[16:19], 0 offen offset:2048
    buffer_load_dword v61, v23, s[16:19], 0 offen offset:3072
    v_add_u32 v22, 0x10000, v22
    buffer_load_dword v42, v22, s[12:15], 0 offen offset:0
    buffer_load_dword v43, v22, s[12:15], 0 offen offset:1024
    buffer_load_dword v44, v22, s[12:15], 0 offen offset:2048
    buffer_load_dword v45, v21, s[12:15], s31 offen offset:0
    buffer_load_dword v46, v21, s[12:15], s31 offen offset:1024
    buffer_load_dword v47, v21, s[12:15], s31 offen offset:2048
    buffer_load_dword v48, v21, s[12:15], s31 offen offset:3072
    buffer_load_dword v49, v23, s[12:15], s31 offen offset:0
    buffer_load_dword v50, v23, s[12:15], s31 offen offset:1024
    buffer_load_dword v51, v23, s[12:15], s31 offen offset:2048
    buffer_load_dword v52, v23, s[12:15], s31 offen offset:3072
    buffer_load_dword v62, v21, s[16:19], s31 offen offset:0
    buffer_load_dword v63, v21, s[16:19], s31 offen offset:1024
    buffer_load_dword v64, v21, s[16:19], s31 offen offset:2048
    buffer_load_dword v65, v21, s[16:19], s31 offen offset:3072
    buffer_load_dword v66, v23, s[16:19], s31 offen offset:0
    buffer_load_dword v67, v23, s[16:19], s31 offen offset:1024
    buffer_load_dword v68, v23, s[16:19], s31 offen offset:2048
    buffer_load_dword v69, v23, s[16:19], s31 offen offset:3072
L_p0:
    v_lshlrev_b32 v24, 7, v1
    v_cmp_gt_u32 vcc, 8, v1
    v_mov_b32 v3, 0xffffff00
    s_nop 0
    v_cndmask_b32 v24, v3, v24, vcc
    s_mul_i32 s3, s66, 18432
    v_and_b32_e64 v3, 31, v1
    v_mul_u32_u24 v21, 144, v3
    v_bfe_u32 v3, v0, 5, 3
    v_lshlrev_b32 v3, 4, v3
    v_sub_u32 v21, v21, v3
    v_add_u32 v21, 112, v21
    v_add_u32_e64 v21, s3, v21
    v_bfe_u32 v3, v0, 3, 5
    v_lshlrev_b32_e64 v23, 13, v3
    v_mul_u32_u24 v22, 144, v3
    v_and_b32_e64 v3, 7, v1
    v_lshl_add_u32 v22, v3, 4, v22
    v_add_u32_e64 v22, s3, v22
    v_lshl_add_u32 v23, v3, 4, v23
    s_lshl_b32 s36, s72, 18
    s_lshl_b32 s4, s71, 7
    s_sub_u32 s36, s36, s4
    s_add_u32 s36, s36, 1052416
    s_lshl_b32 s37, s72, 2
    s_add_u32 s37, s37, s65
    s_lshl_b32 s37, s37, 8
    s_add_u32 s37, s37, s71
    s_lshl_b32 s37, s37, 2
    s_add_u32 s37, s37, 131072
    s_waitcnt vmcnt(19)
    v_lshlrev_b32 v92, 16, v26
    v_lshlrev_b32 v93, 16, v28
    v_and_b32 v94, s63, v26
    v_and_b32 v95, s63, v28
    v_lshlrev_b32 v96, 16, v27
    v_lshlrev_b32 v97, 16, v29
    v_and_b32 v98, s63, v27
    v_and_b32 v99, s63, v29
    v_lshlrev_b32 v70, 16, v30
    v_and_b32 v71, s63, v30
    v_lshlrev_b32 v72, 16, v31
    v_and_b32 v73, s63, v31
    v_lshlrev_b32 v74, 16, v32
    v_and_b32 v75, s63, v32
    v_lshlrev_b32 v76, 16, v33
    v_and_b32 v77, s63, v33
    v_lshlrev_b32 v78, 16, v34
    v_and_b32 v79, s63, v34
    v_lshlrev_b32 v80, 16, v35
    v_and_b32 v81, s63, v35
    v_lshlrev_b32 v82, 16, v36
    v_and_b32 v83, s63, v36
    v_lshlrev_b32 v84, 16, v37
    v_and_b32 v85, s63, v37
    v_lshlrev_b32 v86, 16, v38
    v_and_b32 v87, s63, v38
    v_lshlrev_b32 v88, 16, v39
    v_and_b32 v89, s63, v39
    v_lshlrev_b32 v90, 16, v40
    v_and_b32 v91, s63, v40
    v_lshlrev_b32 v100, 16, v54
    v_and_b32 v101, s63, v54
    v_lshlrev_b32 v102, 16, v55
    v_and_b32 v103, s63, v55
    v_lshlrev_b32 v104, 16, v56
    v_and_b32 v105, s63, v56
    v_lshlrev_b32 v106, 16, v57
    v_and_b32 v107, s63, v57
    v_lshlrev_b32 v108, 16, v58
    v_and_b32 v109, s63, v58
    v_lshlrev_b32 v110, 16, v59
    v_and_b32 v111, s63, v59
    v_lshlrev_b32 v112, 16, v60
    v_and_b32 v113, s63, v60
    v_lshlrev_b32 v114, 16, v61
    v_and_b32_e64 v115, s63, v61
    v_pk_mul_f32 v[132:133], v[70:71], v[98:99]
    v_pk_mul_f32 v[134:135], v[72:73], v[98:99]
    v_pk_fma_f32 v[132:133], v[72:73], v[96:97], v[132:133]
    v_pk_fma_f32 v[134:135], v[74:75], v[96:97], v[134:135]
    v_pk_fma_f32 v[132:133], v[74:75], v[94:95], v[132:133]
    v_pk_fma_f32 v[134:135], v[76:77], v[94:95], v[134:135]
    v_pk_fma_f32 v[132:133], v[76:77], v[92:93], v[132:133]
    v_pk_fma_f32 v[134:135], v[78:79], v[92:93], v[134:135]
    v_pk_mul_f32 v[100:101], v[132:133], v[100:101]
    v_pk_mul_f32 v[102:103], v[134:135], v[102:103]
    v_pk_mul_f32 v[132:133], v[74:75], v[98:99]
    v_pk_mul_f32 v[134:135], v[76:77], v[98:99]
    v_pk_fma_f32 v[132:133], v[76:77], v[96:97], v[132:133]
    v_pk_fma_f32 v[134:135], v[78:79], v[96:97], v[134:135]
    v_pk_fma_f32 v[132:133], v[78:79], v[94:95], v[132:133]
    v_pk_fma_f32 v[134:135], v[80:81], v[94:95], v[134:135]
    v_pk_fma_f32 v[132:133], v[80:81], v[92:93], v[132:133]
    v_pk_fma_f32 v[134:135], v[82:83], v[92:93], v[134:135]
    v_pk_mul_f32 v[104:105], v[132:133], v[104:105]
    v_pk_mul_f32 v[106:107], v[134:135], v[106:107]
    v_pk_mul_f32 v[132:133], v[78:79], v[98:99]
    v_pk_mul_f32 v[134:135], v[80:81], v[98:99]
    v_pk_fma_f32 v[132:133], v[80:81], v[96:97], v[132:133]
    v_pk_fma_f32 v[134:135], v[82:83], v[96:97], v[134:135]
    v_pk_fma_f32 v[132:133], v[82:83], v[94:95], v[132:133]
    v_pk_fma_f32 v[134:135], v[84:85], v[94:95], v[134:135]
    v_pk_fma_f32 v[132:133], v[84:85], v[92:93], v[132:133]
    v_pk_fma_f32 v[134:135], v[86:87], v[92:93], v[134:135]
    v_pk_mul_f32 v[108:109], v[132:133], v[108:109]
    v_pk_mul_f32 v[110:111], v[134:135], v[110:111]
    v_pk_mul_f32 v[132:133], v[82:83], v[98:99]
    v_pk_mul_f32 v[134:135], v[84:85], v[98:99]
    v_pk_fma_f32 v[132:133], v[84:85], v[96:97], v[132:133]
    v_pk_fma_f32 v[134:135], v[86:87], v[96:97], v[134:135]
    v_pk_fma_f32 v[132:133], v[86:87], v[94:95], v[132:133]
    v_pk_fma_f32 v[134:135], v[88:89], v[94:95], v[134:135]
    v_pk_fma_f32 v[132:133], v[88:89], v[92:93], v[132:133]
    v_pk_fma_f32 v[134:135], v[90:91], v[92:93], v[134:135]
    v_pk_mul_f32 v[112:113], v[132:133], v[112:113]
    v_pk_mul_f32 v[114:115], v[134:135], v[114:115]
    v_cvt_pk_bf16_f32 v119, v102, v100
    v_cvt_pk_bf16_f32 v118, v106, v104
    v_cvt_pk_bf16_f32 v117, v110, v108
    v_cvt_pk_bf16_f32 v116, v114, v112
    v_cvt_pk_bf16_f32 v123, v103, v101
    v_cvt_pk_bf16_f32 v122, v107, v105
    v_cvt_pk_bf16_f32 v121, v111, v109
    v_cvt_pk_bf16_f32 v120, v115, v113
    ds_write_b128 v21, v[116:119] offset:0
    ds_write_b128 v21, v[120:123] offset:4608
    s_waitcnt vmcnt(0)
    v_lshlrev_b32 v70, 16, v42
    v_and_b32 v71, s63, v42
    v_lshlrev_b32 v72, 16, v43
    v_and_b32 v73, s63, v43
    v_lshlrev_b32 v74, 16, v44
    v_and_b32 v75, s63, v44
    v_lshlrev_b32 v76, 16, v45
    v_and_b32 v77, s63, v45
    v_lshlrev_b32 v78, 16, v46
    v_and_b32 v79, s63, v46
    v_lshlrev_b32 v80, 16, v47
    v_and_b32 v81, s63, v47
    v_lshlrev_b32 v82, 16, v48
    v_and_b32 v83, s63, v48
    v_lshlrev_b32 v84, 16, v49
    v_and_b32 v85, s63, v49
    v_lshlrev_b32 v86, 16, v50
    v_and_b32 v87, s63, v50
    v_lshlrev_b32 v88, 16, v51
    v_and_b32 v89, s63, v51
    v_lshlrev_b32 v90, 16, v52
    v_and_b32 v91, s63, v52
    v_lshlrev_b32 v100, 16, v62
    v_and_b32 v101, s63, v62
    v_lshlrev_b32 v102, 16, v63
    v_and_b32 v103, s63, v63
    v_lshlrev_b32 v104, 16, v64
    v_and_b32 v105, s63, v64
    v_lshlrev_b32 v106, 16, v65
    v_and_b32 v107, s63, v65
    v_lshlrev_b32 v108, 16, v66
    v_and_b32 v109, s63, v66
    v_lshlrev_b32 v110, 16, v67
    v_and_b32 v111, s63, v67
    v_lshlrev_b32 v112, 16, v68
    v_and_b32 v113, s63, v68
    v_lshlrev_b32 v114, 16, v69
    v_and_b32_e64 v115, s63, v69
    v_pk_mul_f32 v[132:133], v[70:71], v[98:99]
    v_pk_mul_f32 v[134:135], v[72:73], v[98:99]
    v_pk_fma_f32 v[132:133], v[72:73], v[96:97], v[132:133]
    v_pk_fma_f32 v[134:135], v[74:75], v[96:97], v[134:135]
    v_pk_fma_f32 v[132:133], v[74:75], v[94:95], v[132:133]
    v_pk_fma_f32 v[134:135], v[76:77], v[94:95], v[134:135]
    v_pk_fma_f32 v[132:133], v[76:77], v[92:93], v[132:133]
    v_pk_fma_f32 v[134:135], v[78:79], v[92:93], v[134:135]
    v_pk_mul_f32 v[100:101], v[132:133], v[100:101]
    v_pk_mul_f32 v[102:103], v[134:135], v[102:103]
    v_pk_mul_f32 v[132:133], v[74:75], v[98:99]
    v_pk_mul_f32 v[134:135], v[76:77], v[98:99]
    v_pk_fma_f32 v[132:133], v[76:77], v[96:97], v[132:133]
    v_pk_fma_f32 v[134:135], v[78:79], v[96:97], v[134:135]
    v_pk_fma_f32 v[132:133], v[78:79], v[94:95], v[132:133]
    v_pk_fma_f32 v[134:135], v[80:81], v[94:95], v[134:135]
    v_pk_fma_f32 v[132:133], v[80:81], v[92:93], v[132:133]
    v_pk_fma_f32 v[134:135], v[82:83], v[92:93], v[134:135]
    v_pk_mul_f32 v[104:105], v[132:133], v[104:105]
    v_pk_mul_f32 v[106:107], v[134:135], v[106:107]
    v_pk_mul_f32 v[132:133], v[78:79], v[98:99]
    v_pk_mul_f32 v[134:135], v[80:81], v[98:99]
    v_pk_fma_f32 v[132:133], v[80:81], v[96:97], v[132:133]
    v_pk_fma_f32 v[134:135], v[82:83], v[96:97], v[134:135]
    v_pk_fma_f32 v[132:133], v[82:83], v[94:95], v[132:133]
    v_pk_fma_f32 v[134:135], v[84:85], v[94:95], v[134:135]
    v_pk_fma_f32 v[132:133], v[84:85], v[92:93], v[132:133]
    v_pk_fma_f32 v[134:135], v[86:87], v[92:93], v[134:135]
    v_pk_mul_f32 v[108:109], v[132:133], v[108:109]
    v_pk_mul_f32 v[110:111], v[134:135], v[110:111]
    v_pk_mul_f32 v[132:133], v[82:83], v[98:99]
    v_pk_mul_f32 v[134:135], v[84:85], v[98:99]
    v_pk_fma_f32 v[132:133], v[84:85], v[96:97], v[132:133]
    v_pk_fma_f32 v[134:135], v[86:87], v[96:97], v[134:135]
    v_pk_fma_f32 v[132:133], v[86:87], v[94:95], v[132:133]
    v_pk_fma_f32 v[134:135], v[88:89], v[94:95], v[134:135]
    v_pk_fma_f32 v[132:133], v[88:89], v[92:93], v[132:133]
    v_pk_fma_f32 v[134:135], v[90:91], v[92:93], v[134:135]
    v_pk_mul_f32 v[112:113], v[132:133], v[112:113]
    v_pk_mul_f32 v[114:115], v[134:135], v[114:115]
    v_cvt_pk_bf16_f32 v127, v102, v100
    v_cvt_pk_bf16_f32 v126, v106, v104
    v_cvt_pk_bf16_f32 v125, v110, v108
    v_cvt_pk_bf16_f32 v124, v114, v112
    v_cvt_pk_bf16_f32 v131, v103, v101
    v_cvt_pk_bf16_f32 v130, v107, v105
    v_cvt_pk_bf16_f32 v129, v111, v109
    v_cvt_pk_bf16_f32 v128, v115, v113
    ds_write_b128 v21, v[124:127] offset:9216
    ds_write_b128 v21, v[128:131] offset:13824
    v_mov_b32_e64 v12, 1
    ds_write_b32 v19, v12 offset:32
    ds_read_b128 v[8:11], v20 offset:32
    s_waitcnt lgkmcnt(0)
    v_min3_u32 v8, v8, v9, v10
    v_min_u32 v8, v8, v11
    v_cmp_gt_u32 vcc, 1, v8
    s_cbranch_vccnz L_fs_10
L_fr_11:
    ds_read_b128 v[116:119], v22 offset:0
    ds_read_b128 v[120:123], v22 offset:4608
    ds_read_b128 v[124:127], v22 offset:9216
    ds_read_b128 v[128:131], v22 offset:13824
    v_mov_b32_e64 v12, 2
    ds_write_b32 v19, v12 offset:32
    s_waitcnt lgkmcnt(1)
    s_nop 0
    buffer_store_dwordx4 v[116:119], v23, s[52:55], s36 offen offset:128 sc1
    buffer_store_dwordx4 v[124:127], v23, s[52:55], s36 offen offset:0 sc1
    s_add_u32 s36, s36, 4096
    buffer_store_dwordx4 v[120:123], v23, s[52:55], s36 offen offset:128 sc1
    buffer_store_dwordx4 v[128:131], v23, s[52:55], s36 offen offset:0 sc1
    s_cmp_lg_u32 s29, 1
    s_cbranch_scc1 L_nost2
    v_lshlrev_b32_e64 v18, 16, v18
    v_min_u32 v21, 128, v0
    v_lshlrev_b32_e64 v21, 2, v21
    v_add_u32 v21, 161024, v21
    v_mov_b32 v25, 0x3f803f80
    ds_write_b32 v21, v18
    v_lshlrev_b32 v30, 16, v14
    v_and_b32 v31, s63, v14
    v_lshlrev_b32 v32, 16, v15
    v_and_b32 v33, s63, v15
    v_lshlrev_b32 v34, 16, v16
    v_and_b32 v35, s63, v16
    v_lshlrev_b32 v36, 16, v17
    v_and_b32 v37, s63, v17
    v_pk_add_f32 v[22:23], v[30:31], v[32:33]
    v_pk_add_f32 v[46:47], v[34:35], v[36:37]
    s_nop 0
    v_pk_add_f32 v[22:23], v[22:23], v[46:47]
    s_nop 0
    v_add_f32 v22, v22, v23
    s_nop 1
    v_add_f32_dpp v22, v22, v22 row_shr:1 row_mask:0xf bank_mask:0xf bound_ctrl:0
    s_nop 1
    v_add_f32_dpp v22, v22, v22 row_shr:2 row_mask:0xf bank_mask:0xf bound_ctrl:0
    s_nop 1
    v_add_f32_dpp v22, v22, v22 row_shr:4 row_mask:0xf bank_mask:0xf bound_ctrl:0
    s_nop 1
    v_add_f32_dpp v22, v22, v22 row_shr:8 row_mask:0xf bank_mask:0xf bound_ctrl:0
    s_nop 1
    v_add_f32_dpp v22, v22, v22 row_bcast:15 row_mask:0xa bank_mask:0xf
    s_nop 1
    v_add_f32_dpp v22, v22, v22 row_bcast:31 row_mask:0xc bank_mask:0xf
    v_mul_f32 v22, 0x3b000000, v22
    s_nop 0
    v_readlane_b32 s32, v22, 63
    v_readlane_b32 s33, v22, 63
    s_nop 1
    s_nop 0
    v_pk_add_f32 v[38:39], v[30:31], s[32:33] neg_lo:[0,1] neg_hi:[0,1]
    v_pk_add_f32 v[40:41], v[32:33], s[32:33] neg_lo:[0,1] neg_hi:[0,1]
    v_pk_add_f32 v[42:43], v[34:35], s[32:33] neg_lo:[0,1] neg_hi:[0,1]
    v_pk_add_f32 v[44:45], v[36:37], s[32:33] neg_lo:[0,1] neg_hi:[0,1]
    v_pk_mul_f32 v[46:47], v[38:39], v[38:39]
    s_nop 0
    v_pk_fma_f32 v[46:47], v[40:41], v[40:41], v[46:47]
    s_nop 0
    v_pk_fma_f32 v[46:47], v[42:43], v[42:43], v[46:47]
    s_nop 0
    v_pk_fma_f32 v[46:47], v[44:45], v[44:45], v[46:47]
    s_nop 0
    v_add_f32 v46, v46, v47
    s_nop 1
    v_add_f32_dpp v46, v46, v46 row_shr:1 row_mask:0xf bank_mask:0xf bound_ctrl:0
    s_nop 1
    v_add_f32_dpp v46, v46, v46 row_shr:2 row_mask:0xf bank_mask:0xf bound_ctrl:0
    s_nop 1
    v_add_f32_dpp v46, v46, v46 row_shr:4 row_mask:0xf bank_mask:0xf bound_ctrl:0
    s_nop 1
    v_add_f32_dpp v46, v46, v46 row_shr:8 row_mask:0xf bank_mask:0xf bound_ctrl:0
    s_nop 1
    v_add_f32_dpp v46, v46, v46 row_bcast:15 row_mask:0xa bank_mask:0xf
    s_nop 1
    s_nop 0
    v_add_f32_dpp v46, v46, v46 row_bcast:31 row_mask:0xc bank_mask:0xf
    v_mul_f32 v23, 0x3b000000, v46
    v_cvt_pk_bf16_f32 v21, v22, v23
    v_lshlrev_b32 v22, 16, v21
    v_and_b32 v23, s63, v21
    v_add_f32 v23, 0x3727c5ac, v23
    v_cvt_pk_bf16_f32 v21, v22, v23
    v_lshlrev_b32 v22, 16, v21
    v_and_b32 v23, s63, v21
    v_sqrt_f32 v23, v23
    s_nop 0
    v_cvt_pk_bf16_f32 v26, v22, v23
    v_and_b32 v23, s63, v26
    v_rcp_f32 v23, v23
    v_readlane_b32 s32, v22, 63
    v_readlane_b32 s33, v22, 63
    v_readlane_b32 s34, v23, 63
    v_readlane_b32 s35, v23, 63
    v_pk_add_f32 v[38:39], v[30:31], s[32:33] neg_lo:[0,1] neg_hi:[0,1]
    v_pk_add_f32 v[40:41], v[32:33], s[32:33] neg_lo:[0,1] neg_hi:[0,1]
    v_pk_add_f32 v[42:43], v[34:35], s[32:33] neg_lo:[0,1] neg_hi:[0,1]
    v_pk_add_f32 v[44:45], v[36:37], s[32:33] neg_lo:[0,1] neg_hi:[0,1]
    v_cvt_pk_bf16_f32 v21, v38, v39
    v_lshlrev_b32 v38, 16, v21
    v_and_b32 v39, s63, v21
    v_cvt_pk_bf16_f32 v21, v40, v41
    v_lshlrev_b32 v40, 16, v21
    v_and_b32 v41, s63, v21
    v_cvt_pk_bf16_f32 v21, v42, v43
    v_lshlrev_b32 v42, 16, v21
    v_and_b32 v43, s63, v21
    v_cvt_pk_bf16_f32 v21, v44, v45
    v_lshlrev_b32 v44, 16, v21
    v_and_b32 v45, s63, v21
    v_pk_mul_f32 v[38:39], v[38:39], s[34:35]
    v_pk_mul_f32 v[40:41], v[40:41], s[34:35]
    v_pk_mul_f32 v[42:43], v[42:43], s[34:35]
    v_pk_mul_f32 v[44:45], v[44:45], s[34:35]
    v_cvt_pk_bf16_f32 v30, v38, v39
    v_cvt_pk_bf16_f32 v31, v40, v41
    v_cvt_pk_bf16_f32 v32, v42, v43
    v_cvt_pk_bf16_f32 v33, v44, v45
    v_mov_b32 v22, 0
    v_mov_b32_e64 v23, 0
    v_dot2c_f32_bf16 v22, v30, v25
    v_dot2c_f32_bf16 v23, v30, v30
    v_dot2c_f32_bf16 v22, v31, v25
    v_dot2c_f32_bf16 v23, v31, v31
    v_dot2c_f32_bf16 v22, v32, v25
    v_dot2c_f32_bf16 v23, v32, v32
    v_dot2c_f32_bf16 v22, v33, v25
    v_dot2c_f32_bf16 v23, v33, v33
    s_nop 1
    v_add_f32_dpp v22, v22, v22 row_shr:1 row_mask:0xf bank_mask:0xf bound_ctrl:0
    v_add_f32_dpp v23, v23, v23 row_shr:1 row_mask:0xf bank_mask:0xf bound_ctrl:0
    s_nop 0
    v_add_f32_dpp v22, v22, v22 row_shr:2 row_mask:0xf bank_mask:0xf bound_ctrl:0
    v_add_f32_dpp v23, v23, v23 row_shr:2 row_mask:0xf bank_mask:0xf bound_ctrl:0
    s_nop 0
    v_add_f32_dpp v22, v22, v22 row_shr:4 row_mask:0xf bank_mask:0xf bound_ctrl:0
    v_add_f32_dpp v23, v23, v23 row_shr:4 row_mask:0xf bank_mask:0xf bound_ctrl:0
    s_nop 0
    v_add_f32_dpp v22, v22, v22 row_shr:8 row_mask:0xf bank_mask:0xf bound_ctrl:0
    v_add_f32_dpp v23, v23, v23 row_shr:8 row_mask:0xf bank_mask:0xf bound_ctrl:0
    s_nop 0
    v_add_f32_dpp v22, v22, v22 row_bcast:15 row_mask:0xa bank_mask:0xf
    v_add_f32_dpp v23, v23, v23 row_bcast:15 row_mask:0xa bank_mask:0xf
    s_nop 0
    s_nop 0
    v_add_f32_dpp v22, v22, v22 row_bcast:31 row_mask:0xc bank_mask:0xf
    v_add_f32_dpp v23, v23, v23 row_bcast:31 row_mask:0xc bank_mask:0xf
    v_mul_f32 v22, 0x3b000000, v22
    v_mul_f32 v23, 0x3b000000, v23
    v_fma_f32 v23, -v22, v22, v23
    v_max_f32_e64 v23, 0, v23
    v_cvt_pk_bf16_f32 v21, v22, v23
    v_lshlrev_b32 v22, 16, v21
    v_and_b32 v23, s63, v21
    v_add_f32 v23, 0x3727c5ac, v23
    v_cvt_pk_bf16_f32 v21, v22, v23
    v_lshlrev_b32 v22, 16, v21
    v_and_b32 v23, s63, v21
    v_sqrt_f32 v23, v23
    s_nop 0
    v_cvt_pk_bf16_f32 v27, v22, v23
    s_cmp_lg_u32 s62, 7
    s_cbranch_scc1 L_noepw1
    ds_read_b128 v[8:11], v6 offset:208
    s_waitcnt lgkmcnt(0)
    v_min3_u32 v8, v8, v9, v10
    v_min_u32 v8, v8, v11
    v_cmp_gt_u32 vcc, 1, v8
    s_cbranch_vccnz L_fs_13
L_fr_14:
    ds_read_b128 v[8:11], v6 offset:224
    s_waitcnt lgkmcnt(0)
    v_min3_u32 v8, v8, v9, v10
    v_min_u32 v8, v8, v11
    v_cmp_gt_u32 vcc, 1, v8
    s_cbranch_vccnz L_fs_16
L_fr_17:
    ds_read_b32 v8, v6 offset:196
    s_waitcnt lgkmcnt(0)
    v_cmp_gt_u32 vcc, 1, v8
    s_cbranch_vccnz L_fs_19
L_fr_20:
L_noepw1:
    s_lshl_b32 s3, s70, 4
    s_add_u32 s3, s3, 65536
    v_mov_b32 v28, s56
    v_mov_b32 v29, s56
    buffer_store_dwordx4 v[26:29], v4, s[52:55], s3 offen sc1
L_nost2:
    v_mov_b32 v132, s56
    v_mov_b32_e64 v133, s56
    s_waitcnt vmcnt(0)
    buffer_store_dwordx2 v[132:133], v24, s[52:55], s37 offen sc1
    v_mov_b32_e64 v12, 3
    ds_write_b32 v19, v12 offset:32
L_cend:
    s_cmp_lg_u32 s66, 0
    s_cbranch_scc1 L_mainB
    s_branch L_mainA
L_fs_1:
L_fl_3:
    s_sleep 1
    ds_read_b128 v[8:11], v6 offset:208
    s_waitcnt lgkmcnt(0)
    v_min3_u32 v8, v8, v9, v10
    v_min_u32 v8, v8, v11
    v_cmp_gt_u32 vcc, 1, v8
    s_cbranch_vccnz L_fl_3
    s_branch L_fr_2
L_fs_4:
L_fl_6:
    s_sleep 1
    ds_read_b128 v[8:11], v6 offset:224
    s_waitcnt lgkmcnt(0)
    v_min3_u32 v8, v8, v9, v10
    v_min_u32 v8, v8, v11
    v_cmp_gt_u32 vcc, 1, v8
    s_cbranch_vccnz L_fl_6
    s_branch L_fr_5
L_fs_7:
L_fl_9:
    s_sleep 1
    ds_read_b32 v8, v6 offset:196
    s_waitcnt lgkmcnt(0)
    v_cmp_gt_u32 vcc, 1, v8
    s_cbranch_vccnz L_fl_9
    s_branch L_fr_8
L_fs_10:
L_fl_12:
    s_sleep 1
    ds_read_b128 v[8:11], v20 offset:32
    s_waitcnt lgkmcnt(0)
    v_min3_u32 v8, v8, v9, v10
    v_min_u32_e64 v8, v8, v11
    v_cmp_gt_u32 vcc, 1, v8
    s_cbranch_vccnz L_fl_12
    s_branch L_fr_11
L_fs_13:
L_fl_15:
    s_sleep 1
    ds_read_b128 v[8:11], v6 offset:208
    s_waitcnt lgkmcnt(0)
    v_min3_u32 v8, v8, v9, v10
    v_min_u32 v8, v8, v11
    v_cmp_gt_u32 vcc, 1, v8
    s_cbranch_vccnz L_fl_15
    s_branch L_fr_14
L_fs_16:
L_fl_18:
    s_sleep 1
    ds_read_b128 v[8:11], v6 offset:224
    s_waitcnt lgkmcnt(0)
    v_min3_u32 v8, v8, v9, v10
    v_min_u32 v8, v8, v11
    v_cmp_gt_u32 vcc, 1, v8
    s_cbranch_vccnz L_fl_18
    s_branch L_fr_17
L_fs_19:
L_fl_21:
    s_sleep 1
    ds_read_b32 v8, v6 offset:196
    s_waitcnt lgkmcnt(0)
    v_cmp_gt_u32 vcc, 1, v8
    s_cbranch_vccnz L_fl_21
    s_branch L_fr_20
L_loader:
    s_mov_b32 s66, s62
    s_lshl_b32 s44, s5, 1
    s_add_u32 s44, s44, s59
    s_add_u32 s44, s44, s6
    s_and_b32 s7, s5, 1
    s_lshl_b32 s7, s7, 1
    s_cmp_eq_u32 s59, 6
    s_cselect_b32 s7, s7, 0
    s_add_u32 s44, s44, s7
    v_lshrrev_b32 v26, 4, v1
    v_and_b32 v27, 7, v1
    v_xor_b32 v26, v26, v27
    v_lshrrev_b32 v27, 3, v1
    v_lshlrev_b32 v27, 10, v27
    v_lshl_add_u32 v14, v26, 4, v27
    v_xor_b32_e64 v15, 64, v14
    v_add_u32 v15, 7168, v15
    v_add_u32 v16, 14336, v14
    v_add_u32 v17, 14336, v15
    s_lshl_b32 s45, s60, 17
    s_lshl_b32 s46, s61, 6
    v_lshrrev_b32_e64 v26, 4, v1
    v_bfe_u32 v27, v1, 2, 2
    v_xor_b32_e64 v27, v27, v26
    s_sub_u32 s7, 43, s61
    v_cmp_gt_u32 vcc, s7, v27
    v_mul_u32_u24 v26, 2752, v26
    v_lshl_add_u32 v26, v27, 6, v26
    v_and_b32_e64 v27, 3, v1
    v_lshl_add_u32 v26, v27, 4, v26
    v_mov_b32 v27, 0x7ff00000
    v_cndmask_b32 v18, v27, v26, vcc
    s_nop 0
    v_add_u32 v19, 9984, v18
    v_add_u32 v20, 19968, v18
    v_add_u32 v21, 29952, v18
    s_add_u32 s62, s62, 8
    s_mov_b32 s65, 0
    v_mov_b32 v6, 160256
    v_mov_b32_e64 v28, 0
    s_add_u32 s100, s100, ctab-L_pc0
    s_addc_u32 s101, s101, 0
    s_waitcnt lgkmcnt(0)
    s_mov_b32 s10, 0x200000
    s_mov_b32 s11, 0x20000
    s_mov_b32 s34, 1409024
    s_mov_b32 s35, 0x20000
    s_setprio 3
    s_cmp_eq_u32 s69, 0
    s_cbranch_scc1 L_lbusy
    s_barrier
    s_mov_b32 s54, 10878976
    s_mov_b32 s55, 0x20000
    v_cmp_eq_u32 vcc, 63, v1
    v_mov_b32 v4, 0xffffff00
    s_nop 0
    v_cndmask_b32_e64 v4, v4, 0, vcc
    v_mov_b32 v6, 160256
    s_lshl_b32 s3, s65, 2
    v_add_u32 v7, s3, v6
    s_load_dword s56, s[52:53], 0
    v_lshrrev_b32 v3, 4, v1
    v_lshlrev_b32 v3, 1, v3
    v_and_b32 v22, 7, v1
    v_xor_b32 v22, v22, v3
    v_lshrrev_b32 v3, 3, v1
    v_lshlrev_b32 v3, 10, v3
    v_lshl_add_u32 v22, v22, 4, v3
    v_add_u32 v23, 7168, v22
    v_add_u32 v24, 14336, v22
    v_add_u32 v25, 21504, v22
    s_mov_b32 s42, 1409024
    s_mov_b32 s43, 0x20000
    s_mov_b32 s26, 0x200000
    s_mov_b32 s27, 0x20000
    s_lshl_b32 s5, s59, 7
    s_mov_b32 s67, 24
    s_and_b32 s3, s58, 3
    s_lshl_b32 s3, s3, 1
    s_add_u32 s3, s3, s59
    s_and_b32 s3, s3, 7
    s_mul_i32 s68, s3, s67
    s_lshr_b32 s68, s68, 3
    s_lshr_b32 s3, s58, 2
    s_add_u32 s68, s68, s3
    s_cmp_ge_u32 s68, s67
    s_cselect_b32 s3, s67, 0
    s_sub_u32 s68, s68, s3
    s_sub_u32 s67, s67, s68
    s_lshl_b32 s70, s68, 15
    s_add_u32 s70, s70, s5
    s_sub_u32 s72, s70, 786432
    s_mov_b32 s47, 19
    s_and_b32 s3, s58, 3
    s_lshl_b32 s3, s3, 1
    s_add_u32 s3, s3, s59
    s_and_b32 s3, s3, 7
    s_mul_i32 s68, s3, s47
    s_lshr_b32 s68, s68, 3
    s_lshr_b32 s3, s58, 2
    s_add_u32 s68, s68, s3
    s_cmp_ge_u32 s68, s47
    s_cselect_b32 s3, s47, 0
    s_sub_u32 s68, s68, s3
    s_sub_u32 s47, s47, s68
    s_lshl_b32 s71, s68, 15
    s_add_u32 s71, s71, s5
    s_sub_u32 s73, s71, 622592
    s_waitcnt lgkmcnt(0)
    s_add_u32 s56, s56, 0x9e3779b9
    s_mov_b32 s57, s56
    v_mov_b32 v5, s56
    s_cmp_lg_u32 s66, 1
    s_cbranch_scc1 L_sk_22
    v_mov_b32_e64 v12, 1
    ds_write_b32 v6, v12 offset:196
    s_setprio 0
    ds_read_b32 v8, v6 offset:8
    s_waitcnt lgkmcnt(0)
    v_cmp_gt_u32 vcc, 1, v8
    s_cbranch_vccnz L_fs_23
L_fr_24:
    s_branch L_lw2
L_sk_22:
    v_mov_b32 v12, 8
    ds_write_b32 v6, v12 offset:0
    v_mov_b32_e64 v12, 8
    ds_write_b32 v6, v12 offset:4
    s_setprio 0
    s_cmp_lg_u32 s69, 1
    s_cbranch_scc1 L_nkw
    ds_read_b128 v[8:11], v6 offset:32
    s_waitcnt lgkmcnt(0)
    v_min3_u32 v8, v8, v9, v10
    v_min_u32_e64 v8, v8, v11
    v_cmp_gt_u32 vcc, 2, v8
    s_cbranch_vccnz L_fs_26
L_fr_27:
    ds_read_b128 v[8:11], v6 offset:48
    s_waitcnt lgkmcnt(0)
    v_min3_u32 v8, v8, v9, v10
    v_min_u32_e64 v8, v8, v11
    v_cmp_gt_u32 vcc, 2, v8
    s_cbranch_vccnz L_fs_29
L_fr_30:
L_nkw:
    s_lshl_b32 s3, s59, 18
    s_lshl_b32 s4, s58, 13
    s_add_u32 s3, s3, s4
    s_mov_b32 m0, 124864
    s_add_u32 s3, s3, 4
    s_nop 0
    buffer_load_dwordx4 v2, s[24:27], s3 offen offset:0 lds
    buffer_load_dwordx4 v2, s[24:27], s3 offen offset:1024 lds
    buffer_load_dwordx4 v2, s[24:27], s3 offen offset:2048 lds
    buffer_load_dwordx4 v2, s[24:27], s3 offen offset:3072 lds
    s_mov_b32 m0, 129088
    s_add_u32 s3, s3, 4
    s_nop 0
    buffer_load_dwordx4 v2, s[24:27], s3 offen offset:0 lds
    buffer_load_dwordx4 v2, s[24:27], s3 offen offset:1024 lds
    buffer_load_dwordx4 v2, s[24:27], s3 offen offset:2048 lds
    buffer_load_dwordx4 v2, s[24:27], s3 offen offset:3072 lds
    s_mov_b32 m0, 133312
    s_add_u32 s3, s3, 4092
    buffer_load_dwordx4 v2, s[24:27], s3 offen offset:0 lds
    buffer_load_dwordx4 v2, s[24:27], s3 offen offset:1024 lds
    buffer_load_dwordx4 v2, s[24:27], s3 offen offset:2048 lds
    buffer_load_dwordx4 v2, s[24:27], s3 offen offset:3072 lds
    s_mov_b32 m0, 137536
    s_add_u32 s3, s3, 4
    s_nop 0
    buffer_load_dwordx4 v2, s[24:27], s3 offen offset:0 lds
    buffer_load_dwordx4 v2, s[24:27], s3 offen offset:1024 lds
    buffer_load_dwordx4 v2, s[24:27], s3 offen offset:2048 lds
    buffer_load_dwordx4 v2, s[24:27], s3 offen offset:3072 lds
    s_mov_b32 m0, 160264
    s_mov_b64 exec, 1
    global_load_lds_dword v28, s[100:101] offset:4
    s_mov_b64 exec, -1
    s_and_b32 s6, s58, 3
    s_lshr_b32 s7, s58, 2
    s_lshl_b32 s45, s6, 1
    s_lshr_b32 s3, s59, 2
    s_add_u32 s45, s45, s3
    s_cmp_lg_u32 s69, 1
    s_cbranch_scc1 L_nh
    s_lshl_b32 s3, s45, 18
    s_lshl_b32 s4, s7, 15
    s_add_u32 s3, s3, s4
    s_mov_b32 s4, 8
L_pf3:
    s_waitcnt vmcnt(24)
    buffer_load_dwordx4 v[100:103], v2, s[24:27], s3 offen offset:0
    buffer_load_dwordx4 v[104:107], v2, s[24:27], s3 offen offset:1024
    buffer_load_dwordx4 v[108:111], v2, s[24:27], s3 offen offset:2048
    buffer_load_dwordx4 v[112:115], v2, s[24:27], s3 offen offset:3072
    s_add_u32 s3, s3, 4096
    s_sub_u32 s4, s4, 1
    s_cmp_lg_u32 s4, 0
    s_cbranch_scc1 L_pf3
    s_add_u32 s3, s45, s7
    s_and_b32 s3, s3, 7
    s_mul_i32 s3, s3, 176128
    s_mov_b32 s46, 10
L_pf4:
    s_waitcnt vmcnt(24)
    s_nop 0
    buffer_load_dwordx4 v[100:103], v2, s[40:43], s3 offen offset:0
    buffer_load_dwordx4 v[104:107], v2, s[40:43], s3 offen offset:1024
    buffer_load_dwordx4 v[108:111], v2, s[40:43], s3 offen offset:2048
    buffer_load_dwordx4 v[112:115], v2, s[40:43], s3 offen offset:3072
    s_add_u32 s3, s3, 4096
    s_sub_u32 s46, s46, 1
    s_cmp_lg_u32 s46, 0
    s_cbranch_scc1 L_pf4
    s_branch L_pfE
L_nh:
    s_and_b32 s4, s6, 1
    s_mul_i32 s4, s4, 384
    s_add_u32 s4, s4, 384
    s_mul_i32 s45, s7, 5
    s_mov_b32 s46, 43
L_pf2:
    s_lshl_b32 s3, s45, 15
    s_add_u32 s3, s3, s4
    s_waitcnt vmcnt(24)
    buffer_load_dwordx4 v[100:103], v22, s[40:43], s3 offen offset:0
    buffer_load_dwordx4 v[104:107], v23, s[40:43], s3 offen offset:1024
    buffer_load_dwordx4 v[108:111], v24, s[40:43], s3 offen offset:2048
    buffer_load_dwordx4 v[112:115], v25, s[40:43], s3 offen offset:3072
    s_add_u32 s45, s45, 1
    s_cmp_eq_u32 s45, 43
    s_cselect_b32 s45, 0, s45
    s_sub_u32 s46, s46, 1
    s_cmp_lg_u32 s46, 0
    s_cbranch_scc1 L_pf2
L_pfE:
    s_mov_b32 m0, 160260
    s_mov_b64 exec, 1
    global_load_lds_dword v28, s[100:101] offset:4
    s_mov_b64 exec, -1
    s_branch L_lw2
L_lbusy:
    s_cmp_lg_u32 s66, 0
    s_cbranch_scc1 L_sk_32
    s_add_u32 s3, s44, 0
    s_and_b32 s3, s3, 7
    s_lshl_b32 s4, s3, 7
    s_add_u32 s4, s4, s45
    s_mov_b32 m0, 0
    s_nop 0
    s_nop 0
    buffer_load_dwordx4 v14, s[8:11], s4 offen offset:0 lds
    buffer_load_dwordx4 v15, s[8:11], s4 offen offset:1024 lds
    buffer_load_dwordx4 v16, s[8:11], s4 offen offset:2048 lds
    buffer_load_dwordx4 v17, s[8:11], s4 offen offset:3072 lds
    s_mov_b32 m0, 4096
    s_add_u32 s4, s4, 32768
    buffer_load_dwordx4 v14, s[8:11], s4 offen offset:0 lds
    buffer_load_dwordx4 v15, s[8:11], s4 offen offset:1024 lds
    buffer_load_dwordx4 v16, s[8:11], s4 offen offset:2048 lds
    buffer_load_dwordx4 v17, s[8:11], s4 offen offset:3072 lds
    s_mov_b32 m0, 8192
    s_add_u32 s4, s4, 32768
    buffer_load_dwordx4 v14, s[8:11], s4 offen offset:0 lds
    buffer_load_dwordx4 v15, s[8:11], s4 offen offset:1024 lds
    buffer_load_dwordx4 v16, s[8:11], s4 offen offset:2048 lds
    buffer_load_dwordx4 v17, s[8:11], s4 offen offset:3072 lds
    s_mov_b32 m0, 12288
    s_add_u32 s4, s4, 32768
    buffer_load_dwordx4 v14, s[8:11], s4 offen offset:0 lds
    buffer_load_dwordx4 v15, s[8:11], s4 offen offset:1024 lds
    buffer_load_dwordx4 v16, s[8:11], s4 offen offset:2048 lds
    buffer_load_dwordx4 v17, s[8:11], s4 offen offset:3072 lds
L_sk_32:
    s_barrier
    s_cmp_lg_u32 s66, 0
    s_cbranch_scc1 L_sk_33
    s_add_u32 s3, s44, 0
    s_and_b32 s3, s3, 7
    s_mul_i32 s3, s3, 176128
    s_add_u32 s3, s3, s46
    s_mov_b32 m0, 65536
    s_nop 0
    s_nop 0
    buffer_load_dwordx4 v18, s[32:35], s3 offen offset:0 lds
    buffer_load_dwordx4 v19, s[32:35], s3 offen offset:1024 lds
    buffer_load_dwordx4 v20, s[32:35], s3 offen offset:2048 lds
    buffer_load_dwordx4 v21, s[32:35], s3 offen offset:3072 lds
    s_mov_b32 m0, 69632
    s_add_u32 s3, s3, 44032
    buffer_load_dwordx4 v18, s[32:35], s3 offen offset:0 lds
    buffer_load_dwordx4 v19, s[32:35], s3 offen offset:1024 lds
    buffer_load_dwordx4 v20, s[32:35], s3 offen offset:2048 lds
    buffer_load_dwordx4 v21, s[32:35], s3 offen offset:3072 lds
    s_mov_b32 m0, 73728
    s_add_u32 s3, s3, 44032
    buffer_load_dwordx4 v18, s[32:35], s3 offen offset:0 lds
    buffer_load_dwordx4 v19, s[32:35], s3 offen offset:1024 lds
    buffer_load_dwordx4 v20, s[32:35], s3 offen offset:2048 lds
    buffer_load_dwordx4 v21, s[32:35], s3 offen offset:3072 lds
    s_mov_b32 m0, 77824
    s_add_u32 s3, s3, 44032
    buffer_load_dwordx4 v18, s[32:35], s3 offen offset:0 lds
    buffer_load_dwordx4 v19, s[32:35], s3 offen offset:1024 lds
    buffer_load_dwordx4 v20, s[32:35], s3 offen offset:2048 lds
    buffer_load_dwordx4 v21, s[32:35], s3 offen offset:3072 lds
    s_mov_b32 m0, 160252
    s_mov_b64 exec, 1
    global_load_lds_dword v28, s[100:101] offset:4
    s_mov_b64 exec, -1
L_sk_33:
    s_mov_b32 s54, 10878976
    s_mov_b32 s55, 0x20000
    v_cmp_eq_u32 vcc, 63, v1
    v_mov_b32 v4, 0xffffff00
    s_nop 0
    v_cndmask_b32_e64 v4, v4, 0, vcc
    v_mov_b32 v6, 160256
    s_lshl_b32 s3, s65, 2
    v_add_u32 v7, s3, v6
    s_load_dword s56, s[52:53], 0
    v_lshrrev_b32 v3, 4, v1
    v_lshlrev_b32 v3, 1, v3
    v_and_b32 v22, 7, v1
    v_xor_b32 v22, v22, v3
    v_lshrrev_b32 v3, 3, v1
    v_lshlrev_b32 v3, 10, v3
    v_lshl_add_u32 v22, v22, 4, v3
    v_add_u32 v23, 7168, v22
    v_add_u32 v24, 14336, v22
    v_add_u32 v25, 21504, v22
    s_mov_b32 s42, 1409024
    s_mov_b32 s43, 0x20000
    s_mov_b32 s26, 0x200000
    s_mov_b32 s27, 0x20000
    s_lshl_b32 s5, s59, 7
    s_mov_b32 s67, 24
    s_and_b32 s3, s58, 3
    s_lshl_b32 s3, s3, 1
    s_add_u32 s3, s3, s59
    s_and_b32 s3, s3, 7
    s_mul_i32 s68, s3, s67
    s_lshr_b32 s68, s68, 3
    s_lshr_b32 s3, s58, 2
    s_add_u32 s68, s68, s3
    s_cmp_ge_u32 s68, s67
    s_cselect_b32 s3, s67, 0
    s_sub_u32 s68, s68, s3
    s_sub_u32 s67, s67, s68
    s_lshl_b32 s70, s68, 15
    s_add_u32 s70, s70, s5
    s_sub_u32 s72, s70, 786432
    s_mov_b32 s47, 19
    s_and_b32 s3, s58, 3
    s_lshl_b32 s3, s3, 1
    s_add_u32 s3, s3, s59
    s_and_b32 s3, s3, 7
    s_mul_i32 s68, s3, s47
    s_lshr_b32 s68, s68, 3
    s_lshr_b32 s3, s58, 2
    s_add_u32 s68, s68, s3
    s_cmp_ge_u32 s68, s47
    s_cselect_b32 s3, s47, 0
    s_sub_u32 s68, s68, s3
    s_sub_u32 s47, s47, s68
    s_lshl_b32 s71, s68, 15
    s_add_u32 s71, s71, s5
    s_sub_u32 s73, s71, 622592
    s_waitcnt lgkmcnt(0)
    s_add_u32 s56, s56, 0x9e3779b9
    s_mov_b32 s57, s56
    v_mov_b32 v5, s56
    s_cmp_lg_u32 s66, 1
    s_cbranch_scc1 L_sk_34
    v_mov_b32_e64 v12, 1
    ds_write_b32 v6, v12 offset:196
    s_add_u32 s3, s44, 1
    s_and_b32 s3, s3, 7
    s_mul_i32 s3, s3, 176128
    s_add_u32 s3, s3, s46
    s_mov_b32 m0, 81920
    s_nop 0
    buffer_load_dwordx4 v18, s[32:35], s3 offen offset:0 lds
    buffer_load_dwordx4 v19, s[32:35], s3 offen offset:1024 lds
    buffer_load_dwordx4 v20, s[32:35], s3 offen offset:2048 lds
    buffer_load_dwordx4 v21, s[32:35], s3 offen offset:3072 lds
    s_mov_b32 m0, 86016
    s_add_u32 s3, s3, 44032
    buffer_load_dwordx4 v18, s[32:35], s3 offen offset:0 lds
    buffer_load_dwordx4 v19, s[32:35], s3 offen offset:1024 lds
    buffer_load_dwordx4 v20, s[32:35], s3 offen offset:2048 lds
    buffer_load_dwordx4 v21, s[32:35], s3 offen offset:3072 lds
    s_mov_b32 m0, 90112
    s_add_u32 s3, s3, 44032
    buffer_load_dwordx4 v18, s[32:35], s3 offen offset:0 lds
    buffer_load_dwordx4 v19, s[32:35], s3 offen offset:1024 lds
    buffer_load_dwordx4 v20, s[32:35], s3 offen offset:2048 lds
    buffer_load_dwordx4 v21, s[32:35], s3 offen offset:3072 lds
    s_mov_b32 m0, 94208
    s_add_u32 s3, s3, 44032
    buffer_load_dwordx4 v18, s[32:35], s3 offen offset:0 lds
    buffer_load_dwordx4 v19, s[32:35], s3 offen offset:1024 lds
    buffer_load_dwordx4 v20, s[32:35], s3 offen offset:2048 lds
    buffer_load_dwordx4 v21, s[32:35], s3 offen offset:3072 lds
    s_add_u32 s3, s44, 1
    s_and_b32 s3, s3, 7
    s_lshl_b32 s4, s3, 7
    s_add_u32 s4, s4, s45
    s_mov_b32 m0, 16384
    s_nop 0
    s_nop 0
    buffer_load_dwordx4 v14, s[8:11], s4 offen offset:0 lds
    buffer_load_dwordx4 v15, s[8:11], s4 offen offset:1024 lds
    buffer_load_dwordx4 v16, s[8:11], s4 offen offset:2048 lds
    buffer_load_dwordx4 v17, s[8:11], s4 offen offset:3072 lds
    s_mov_b32 m0, 20480
    s_add_u32 s4, s4, 32768
    buffer_load_dwordx4 v14, s[8:11], s4 offen offset:0 lds
    buffer_load_dwordx4 v15, s[8:11], s4 offen offset:1024 lds
    buffer_load_dwordx4 v16, s[8:11], s4 offen offset:2048 lds
    buffer_load_dwordx4 v17, s[8:11], s4 offen offset:3072 lds
    s_mov_b32 m0, 24576
    s_add_u32 s4, s4, 32768
    buffer_load_dwordx4 v14, s[8:11], s4 offen offset:0 lds
    buffer_load_dwordx4 v15, s[8:11], s4 offen offset:1024 lds
    buffer_load_dwordx4 v16, s[8:11], s4 offen offset:2048 lds
    buffer_load_dwordx4 v17, s[8:11], s4 offen offset:3072 lds
    s_mov_b32 m0, 28672
    s_add_u32 s4, s4, 32768
    buffer_load_dwordx4 v14, s[8:11], s4 offen offset:0 lds
    buffer_load_dwordx4 v15, s[8:11], s4 offen offset:1024 lds
    buffer_load_dwordx4 v16, s[8:11], s4 offen offset:2048 lds
    buffer_load_dwordx4 v17, s[8:11], s4 offen offset:3072 lds
    s_mov_b32 m0, 160252
    s_mov_b64 exec, 1
    global_load_lds_dword v28, s[100:101] offset:8
    s_mov_b64 exec, -1
L_sk_34:
    s_cmp_lg_u32 s66, 0
    s_cbranch_scc1 L_sk_35
    s_waitcnt vmcnt(8)
    s_setprio 2
    s_add_u32 s3, s44, 2
    s_and_b32 s3, s3, 7
    s_lshl_b32 s4, s3, 7
    s_add_u32 s4, s4, s45
    s_waitcnt vmcnt(8)
    s_mov_b32 m0, 32768
    s_nop 0
    buffer_load_dwordx4 v14, s[8:11], s4 offen offset:0 lds
    buffer_load_dwordx4 v15, s[8:11], s4 offen offset:1024 lds
    buffer_load_dwordx4 v16, s[8:11], s4 offen offset:2048 lds
    buffer_load_dwordx4 v17, s[8:11], s4 offen offset:3072 lds
    s_waitcnt vmcnt(8)
    s_nop 0
    s_mov_b32 m0, 36864
    s_add_u32 s4, s4, 32768
    buffer_load_dwordx4 v14, s[8:11], s4 offen offset:0 lds
    buffer_load_dwordx4 v15, s[8:11], s4 offen offset:1024 lds
    buffer_load_dwordx4 v16, s[8:11], s4 offen offset:2048 lds
    buffer_load_dwordx4 v17, s[8:11], s4 offen offset:3072 lds
    s_waitcnt vmcnt(8)
    s_nop 0
    s_mov_b32 m0, 40960
    s_add_u32 s4, s4, 32768
    buffer_load_dwordx4 v14, s[8:11], s4 offen offset:0 lds
    buffer_load_dwordx4 v15, s[8:11], s4 offen offset:1024 lds
    buffer_load_dwordx4 v16, s[8:11], s4 offen offset:2048 lds
    buffer_load_dwordx4 v17, s[8:11], s4 offen offset:3072 lds
    s_waitcnt vmcnt(8)
    s_nop 0
    s_mov_b32 m0, 45056
    s_add_u32 s4, s4, 32768
    buffer_load_dwordx4 v14, s[8:11], s4 offen offset:0 lds
    buffer_load_dwordx4 v15, s[8:11], s4 offen offset:1024 lds
    buffer_load_dwordx4 v16, s[8:11], s4 offen offset:2048 lds
    buffer_load_dwordx4 v17, s[8:11], s4 offen offset:3072 lds
    s_setprio 3
    s_add_u32 s3, s44, 2
    s_and_b32 s3, s3, 7
    s_mul_i32 s3, s3, 176128
    s_add_u32 s3, s3, s46
    s_waitcnt vmcnt(8)
    s_mov_b32 m0, 98304
    s_nop 0
    buffer_load_dwordx4 v18, s[32:35], s3 offen offset:0 lds
    buffer_load_dwordx4 v19, s[32:35], s3 offen offset:1024 lds
    buffer_load_dwordx4 v20, s[32:35], s3 offen offset:2048 lds
    buffer_load_dwordx4 v21, s[32:35], s3 offen offset:3072 lds
    s_waitcnt vmcnt(8)
    s_nop 0
    s_mov_b32 m0, 102400
    s_add_u32 s3, s3, 44032
    buffer_load_dwordx4 v18, s[32:35], s3 offen offset:0 lds
    buffer_load_dwordx4 v19, s[32:35], s3 offen offset:1024 lds
    buffer_load_dwordx4 v20, s[32:35], s3 offen offset:2048 lds
    buffer_load_dwordx4 v21, s[32:35], s3 offen offset:3072 lds
    s_waitcnt vmcnt(8)
    s_nop 0
    s_mov_b32 m0, 106496
    s_add_u32 s3, s3, 44032
    buffer_load_dwordx4 v18, s[32:35], s3 offen offset:0 lds
    buffer_load_dwordx4 v19, s[32:35], s3 offen offset:1024 lds
    buffer_load_dwordx4 v20, s[32:35], s3 offen offset:2048 lds
    buffer_load_dwordx4 v21, s[32:35], s3 offen offset:3072 lds
    s_waitcnt vmcnt(8)
    s_nop 0
    s_mov_b32 m0, 110592
    s_add_u32 s3, s3, 44032
    buffer_load_dwordx4 v18, s[32:35], s3 offen offset:0 lds
    buffer_load_dwordx4 v19, s[32:35], s3 offen offset:1024 lds
    buffer_load_dwordx4 v20, s[32:35], s3 offen offset:2048 lds
    buffer_load_dwordx4 v21, s[32:35], s3 offen offset:3072 lds
    s_mov_b32 m0, 160244
    s_mov_b64 exec, 1
    global_load_lds_dword v28, s[100:101] offset:12
    s_mov_b64 exec, -1
L_sk_35:
    s_cmp_lg_u32 s66, 1
    s_cbranch_scc1 L_sk_36
    s_waitcnt vmcnt(8)
    s_setprio 2
    s_add_u32 s3, s44, 3
    s_and_b32 s3, s3, 7
    s_lshl_b32 s4, s3, 7
    s_add_u32 s4, s4, s45
    s_waitcnt vmcnt(8)
    s_mov_b32 m0, 49152
    s_nop 0
    buffer_load_dwordx4 v14, s[8:11], s4 offen offset:0 lds
    buffer_load_dwordx4 v15, s[8:11], s4 offen offset:1024 lds
    buffer_load_dwordx4 v16, s[8:11], s4 offen offset:2048 lds
    buffer_load_dwordx4 v17, s[8:11], s4 offen offset:3072 lds
    s_waitcnt vmcnt(8)
    s_nop 0
    s_mov_b32 m0, 53248
    s_add_u32 s4, s4, 32768
    buffer_load_dwordx4 v14, s[8:11], s4 offen offset:0 lds
    buffer_load_dwordx4 v15, s[8:11], s4 offen offset:1024 lds
    buffer_load_dwordx4 v16, s[8:11], s4 offen offset:2048 lds
    buffer_load_dwordx4 v17, s[8:11], s4 offen offset:3072 lds
    s_waitcnt vmcnt(8)
    s_nop 0
    s_mov_b32 m0, 57344
    s_add_u32 s4, s4, 32768
    buffer_load_dwordx4 v14, s[8:11], s4 offen offset:0 lds
    buffer_load_dwordx4 v15, s[8:11], s4 offen offset:1024 lds
    buffer_load_dwordx4 v16, s[8:11], s4 offen offset:2048 lds
    buffer_load_dwordx4 v17, s[8:11], s4 offen offset:3072 lds
    s_waitcnt vmcnt(8)
    s_nop 0
    s_mov_b32 m0, 61440
    s_add_u32 s4, s4, 32768
    buffer_load_dwordx4 v14, s[8:11], s4 offen offset:0 lds
    buffer_load_dwordx4 v15, s[8:11], s4 offen offset:1024 lds
    buffer_load_dwordx4 v16, s[8:11], s4 offen offset:2048 lds
    buffer_load_dwordx4 v17, s[8:11], s4 offen offset:3072 lds
    s_setprio 3
    s_add_u32 s3, s44, 3
    s_and_b32 s3, s3, 7
    s_mul_i32 s3, s3, 176128
    s_add_u32 s3, s3, s46
    s_waitcnt vmcnt(8)
    s_mov_b32 m0, 114688
    s_nop 0
    buffer_load_dwordx4 v18, s[32:35], s3 offen offset:0 lds
    buffer_load_dwordx4 v19, s[32:35], s3 offen offset:1024 lds
    buffer_load_dwordx4 v20, s[32:35], s3 offen offset:2048 lds
    buffer_load_dwordx4 v21, s[32:35], s3 offen offset:3072 lds
    s_waitcnt vmcnt(8)
    s_nop 0
    s_mov_b32 m0, 118784
    s_add_u32 s3, s3, 44032
    buffer_load_dwordx4 v18, s[32:35], s3 offen offset:0 lds
    buffer_load_dwordx4 v19, s[32:35], s3 offen offset:1024 lds
    buffer_load_dwordx4 v20, s[32:35], s3 offen offset:2048 lds
    buffer_load_dwordx4 v21, s[32:35], s3 offen offset:3072 lds
    s_waitcnt vmcnt(8)
    s_nop 0
    s_mov_b32 m0, 122880
    s_add_u32 s3, s3, 44032
    buffer_load_dwordx4 v18, s[32:35], s3 offen offset:0 lds
    buffer_load_dwordx4 v19, s[32:35], s3 offen offset:1024 lds
    buffer_load_dwordx4 v20, s[32:35], s3 offen offset:2048 lds
    buffer_load_dwordx4 v21, s[32:35], s3 offen offset:3072 lds
    s_waitcnt vmcnt(8)
    s_nop 0
    s_mov_b32 m0, 126976
    s_add_u32 s3, s3, 44032
    buffer_load_dwordx4 v18, s[32:35], s3 offen offset:0 lds
    buffer_load_dwordx4 v19, s[32:35], s3 offen offset:1024 lds
    buffer_load_dwordx4 v20, s[32:35], s3 offen offset:2048 lds
    buffer_load_dwordx4 v21, s[32:35], s3 offen offset:3072 lds
    s_mov_b32 m0, 160244
    s_mov_b64 exec, 1
    global_load_lds_dword v28, s[100:101] offset:16
    s_mov_b64 exec, -1
L_sk_36:
    s_cmp_lg_u32 s66, 0
    s_cbranch_scc1 L_sk_37
    s_setprio 0
    ds_read_b128 v[8:11], v6 offset:16
    s_waitcnt lgkmcnt(0)
    v_min3_u32 v8, v8, v9, v10
    v_min_u32 v8, v8, v11
    v_cmp_gt_u32 vcc, 1, v8
    s_cbranch_vccnz L_fs_38
L_fr_39:
    s_setprio 3
    s_setprio 2
    s_add_u32 s3, s44, 4
    s_and_b32 s3, s3, 7
    s_lshl_b32 s4, s3, 7
    s_add_u32 s4, s4, s45
    s_waitcnt vmcnt(8)
    s_mov_b32 m0, 0
    s_nop 0
    buffer_load_dwordx4 v14, s[8:11], s4 offen offset:0 lds
    buffer_load_dwordx4 v15, s[8:11], s4 offen offset:1024 lds
    buffer_load_dwordx4 v16, s[8:11], s4 offen offset:2048 lds
    buffer_load_dwordx4 v17, s[8:11], s4 offen offset:3072 lds
    s_waitcnt vmcnt(8)
    s_nop 0
    s_mov_b32 m0, 4096
    s_add_u32 s4, s4, 32768
    buffer_load_dwordx4 v14, s[8:11], s4 offen offset:0 lds
    buffer_load_dwordx4 v15, s[8:11], s4 offen offset:1024 lds
    buffer_load_dwordx4 v16, s[8:11], s4 offen offset:2048 lds
    buffer_load_dwordx4 v17, s[8:11], s4 offen offset:3072 lds
    s_waitcnt vmcnt(8)
    s_nop 0
    s_mov_b32 m0, 8192
    s_add_u32 s4, s4, 32768
    buffer_load_dwordx4 v14, s[8:11], s4 offen offset:0 lds
    buffer_load_dwordx4 v15, s[8:11], s4 offen offset:1024 lds
    buffer_load_dwordx4 v16, s[8:11], s4 offen offset:2048 lds
    buffer_load_dwordx4 v17, s[8:11], s4 offen offset:3072 lds
    s_waitcnt vmcnt(8)
    s_nop 0
    s_mov_b32 m0, 12288
    s_add_u32 s4, s4, 32768
    buffer_load_dwordx4 v14, s[8:11], s4 offen offset:0 lds
    buffer_load_dwordx4 v15, s[8:11], s4 offen offset:1024 lds
    buffer_load_dwordx4 v16, s[8:11], s4 offen offset:2048 lds
    buffer_load_dwordx4 v17, s[8:11], s4 offen offset:3072 lds
    s_setprio 3
    s_add_u32 s3, s44, 4
    s_and_b32 s3, s3, 7
    s_mul_i32 s3, s3, 176128
    s_add_u32 s3, s3, s46
    s_waitcnt vmcnt(8)
    s_mov_b32 m0, 65536
    s_nop 0
    buffer_load_dwordx4 v18, s[32:35], s3 offen offset:0 lds
    buffer_load_dwordx4 v19, s[32:35], s3 offen offset:1024 lds
    buffer_load_dwordx4 v20, s[32:35], s3 offen offset:2048 lds
    buffer_load_dwordx4 v21, s[32:35], s3 offen offset:3072 lds
    s_waitcnt vmcnt(8)
    s_nop 0
    s_mov_b32 m0, 69632
    s_add_u32 s3, s3, 44032
    buffer_load_dwordx4 v18, s[32:35], s3 offen offset:0 lds
    buffer_load_dwordx4 v19, s[32:35], s3 offen offset:1024 lds
    buffer_load_dwordx4 v20, s[32:35], s3 offen offset:2048 lds
    buffer_load_dwordx4 v21, s[32:35], s3 offen offset:3072 lds
    s_waitcnt vmcnt(8)
    s_nop 0
    s_mov_b32 m0, 73728
    s_add_u32 s3, s3, 44032
    buffer_load_dwordx4 v18, s[32:35], s3 offen offset:0 lds
    buffer_load_dwordx4 v19, s[32:35], s3 offen offset:1024 lds
    buffer_load_dwordx4 v20, s[32:35], s3 offen offset:2048 lds
    buffer_load_dwordx4 v21, s[32:35], s3 offen offset:3072 lds
    s_waitcnt vmcnt(8)
    s_nop 0
    s_mov_b32 m0, 77824
    s_add_u32 s3, s3, 44032
    buffer_load_dwordx4 v18, s[32:35], s3 offen offset:0 lds
    buffer_load_dwordx4 v19, s[32:35], s3 offen offset:1024 lds
    buffer_load_dwordx4 v20, s[32:35], s3 offen offset:2048 lds
    buffer_load_dwordx4 v21, s[32:35], s3 offen offset:3072 lds
    s_mov_b32 m0, 160236
    s_mov_b64 exec, 1
    global_load_lds_dword v28, s[100:101] offset:20
    s_mov_b64 exec, -1
L_sk_37:
    s_cmp_lg_u32 s66, 1
    s_cbranch_scc1 L_sk_41
    s_setprio 0
    ds_read_b128 v[8:11], v6 offset:16
    s_waitcnt lgkmcnt(0)
    v_min3_u32 v8, v8, v9, v10
    v_min_u32 v8, v8, v11
    v_cmp_gt_u32 vcc, 2, v8
    s_cbranch_vccnz L_fs_42
L_fr_43:
    s_setprio 3
    s_setprio 2
    s_add_u32 s3, s44, 5
    s_and_b32 s3, s3, 7
    s_lshl_b32 s4, s3, 7
    s_add_u32 s4, s4, s45
    s_waitcnt vmcnt(8)
    s_mov_b32 m0, 16384
    s_nop 0
    s_nop 0
    buffer_load_dwordx4 v14, s[8:11], s4 offen offset:0 lds
    buffer_load_dwordx4 v15, s[8:11], s4 offen offset:1024 lds
    buffer_load_dwordx4 v16, s[8:11], s4 offen offset:2048 lds
    buffer_load_dwordx4 v17, s[8:11], s4 offen offset:3072 lds
    s_waitcnt vmcnt(8)
    s_nop 0
    s_mov_b32 m0, 20480
    s_add_u32 s4, s4, 32768
    buffer_load_dwordx4 v14, s[8:11], s4 offen offset:0 lds
    buffer_load_dwordx4 v15, s[8:11], s4 offen offset:1024 lds
    buffer_load_dwordx4 v16, s[8:11], s4 offen offset:2048 lds
    buffer_load_dwordx4 v17, s[8:11], s4 offen offset:3072 lds
    s_waitcnt vmcnt(8)
    s_nop 0
    s_mov_b32 m0, 24576
    s_add_u32 s4, s4, 32768
    buffer_load_dwordx4 v14, s[8:11], s4 offen offset:0 lds
    buffer_load_dwordx4 v15, s[8:11], s4 offen offset:1024 lds
    buffer_load_dwordx4 v16, s[8:11], s4 offen offset:2048 lds
    buffer_load_dwordx4 v17, s[8:11], s4 offen offset:3072 lds
    s_waitcnt vmcnt(8)
    s_nop 0
    s_mov_b32 m0, 28672
    s_add_u32 s4, s4, 32768
    buffer_load_dwordx4 v14, s[8:11], s4 offen offset:0 lds
    buffer_load_dwordx4 v15, s[8:11], s4 offen offset:1024 lds
    buffer_load_dwordx4 v16, s[8:11], s4 offen offset:2048 lds
    buffer_load_dwordx4 v17, s[8:11], s4 offen offset:3072 lds
    s_setprio 3
    s_add_u32 s3, s44, 5
    s_and_b32 s3, s3, 7
    s_mul_i32 s3, s3, 176128
    s_add_u32 s3, s3, s46
    s_waitcnt vmcnt(8)
    s_mov_b32 m0, 81920
    s_nop 0
    buffer_load_dwordx4 v18, s[32:35], s3 offen offset:0 lds
    buffer_load_dwordx4 v19, s[32:35], s3 offen offset:1024 lds
    buffer_load_dwordx4 v20, s[32:35], s3 offen offset:2048 lds
    buffer_load_dwordx4 v21, s[32:35], s3 offen offset:3072 lds
    s_waitcnt vmcnt(8)
    s_nop 0
    s_mov_b32 m0, 86016
    s_add_u32 s3, s3, 44032
    buffer_load_dwordx4 v18, s[32:35], s3 offen offset:0 lds
    buffer_load_dwordx4 v19, s[32:35], s3 offen offset:1024 lds
    buffer_load_dwordx4 v20, s[32:35], s3 offen offset:2048 lds
    buffer_load_dwordx4 v21, s[32:35], s3 offen offset:3072 lds
    s_waitcnt vmcnt(8)
    s_nop 0
    s_mov_b32 m0, 90112
    s_add_u32 s3, s3, 44032
    buffer_load_dwordx4 v18, s[32:35], s3 offen offset:0 lds
    buffer_load_dwordx4 v19, s[32:35], s3 offen offset:1024 lds
    buffer_load_dwordx4 v20, s[32:35], s3 offen offset:2048 lds
    buffer_load_dwordx4 v21, s[32:35], s3 offen offset:3072 lds
    s_waitcnt vmcnt(8)
    s_nop 0
    s_mov_b32 m0, 94208
    s_add_u32 s3, s3, 44032
    buffer_load_dwordx4 v18, s[32:35], s3 offen offset:0 lds
    buffer_load_dwordx4 v19, s[32:35], s3 offen offset:1024 lds
    buffer_load_dwordx4 v20, s[32:35], s3 offen offset:2048 lds
    buffer_load_dwordx4 v21, s[32:35], s3 offen offset:3072 lds
    s_mov_b32 m0, 160236
    s_mov_b64 exec, 1
    global_load_lds_dword v28, s[100:101] offset:24
    s_mov_b64 exec, -1
L_sk_41:
    s_cmp_lg_u32 s66, 0
    s_cbranch_scc1 L_sk_45
    s_setprio 0
    ds_read_b128 v[8:11], v6 offset:16
    s_waitcnt lgkmcnt(0)
    v_min3_u32 v8, v8, v9, v10
    v_min_u32 v8, v8, v11
    v_cmp_gt_u32 vcc, 3, v8
    s_cbranch_vccnz L_fs_46
L_fr_47:
    s_setprio 3
    s_setprio 2
    s_add_u32 s3, s44, 6
    s_and_b32 s3, s3, 7
    s_lshl_b32 s4, s3, 7
    s_add_u32 s4, s4, s45
    s_waitcnt vmcnt(8)
    s_mov_b32 m0, 32768
    s_nop 0
    s_nop 0
    buffer_load_dwordx4 v14, s[8:11], s4 offen offset:0 lds
    buffer_load_dwordx4 v15, s[8:11], s4 offen offset:1024 lds
    buffer_load_dwordx4 v16, s[8:11], s4 offen offset:2048 lds
    buffer_load_dwordx4 v17, s[8:11], s4 offen offset:3072 lds
    s_waitcnt vmcnt(8)
    s_nop 0
    s_mov_b32 m0, 36864
    s_add_u32 s4, s4, 32768
    buffer_load_dwordx4 v14, s[8:11], s4 offen offset:0 lds
    buffer_load_dwordx4 v15, s[8:11], s4 offen offset:1024 lds
    buffer_load_dwordx4 v16, s[8:11], s4 offen offset:2048 lds
    buffer_load_dwordx4 v17, s[8:11], s4 offen offset:3072 lds
    s_waitcnt vmcnt(8)
    s_nop 0
    s_mov_b32 m0, 40960
    s_add_u32 s4, s4, 32768
    buffer_load_dwordx4 v14, s[8:11], s4 offen offset:0 lds
    buffer_load_dwordx4 v15, s[8:11], s4 offen offset:1024 lds
    buffer_load_dwordx4 v16, s[8:11], s4 offen offset:2048 lds
    buffer_load_dwordx4 v17, s[8:11], s4 offen offset:3072 lds
    s_waitcnt vmcnt(8)
    s_nop 0
    s_mov_b32 m0, 45056
    s_add_u32 s4, s4, 32768
    buffer_load_dwordx4 v14, s[8:11], s4 offen offset:0 lds
    buffer_load_dwordx4 v15, s[8:11], s4 offen offset:1024 lds
    buffer_load_dwordx4 v16, s[8:11], s4 offen offset:2048 lds
    buffer_load_dwordx4 v17, s[8:11], s4 offen offset:3072 lds
    s_setprio 3
    s_add_u32 s3, s44, 6
    s_and_b32 s3, s3, 7
    s_mul_i32 s3, s3, 176128
    s_add_u32 s3, s3, s46
    s_waitcnt vmcnt(8)
    s_mov_b32 m0, 98304
    s_nop 0
    buffer_load_dwordx4 v18, s[32:35], s3 offen offset:0 lds
    buffer_load_dwordx4 v19, s[32:35], s3 offen offset:1024 lds
    buffer_load_dwordx4 v20, s[32:35], s3 offen offset:2048 lds
    buffer_load_dwordx4 v21, s[32:35], s3 offen offset:3072 lds
    s_waitcnt vmcnt(8)
    s_nop 0
    s_mov_b32 m0, 102400
    s_add_u32 s3, s3, 44032
    buffer_load_dwordx4 v18, s[32:35], s3 offen offset:0 lds
    buffer_load_dwordx4 v19, s[32:35], s3 offen offset:1024 lds
    buffer_load_dwordx4 v20, s[32:35], s3 offen offset:2048 lds
    buffer_load_dwordx4 v21, s[32:35], s3 offen offset:3072 lds
    s_waitcnt vmcnt(8)
    s_nop 0
    s_mov_b32 m0, 106496
    s_add_u32 s3, s3, 44032
    buffer_load_dwordx4 v18, s[32:35], s3 offen offset:0 lds
    buffer_load_dwordx4 v19, s[32:35], s3 offen offset:1024 lds
    buffer_load_dwordx4 v20, s[32:35], s3 offen offset:2048 lds
    buffer_load_dwordx4 v21, s[32:35], s3 offen offset:3072 lds
    s_waitcnt vmcnt(8)
    s_nop 0
    s_mov_b32 m0, 110592
    s_add_u32 s3, s3, 44032
    buffer_load_dwordx4 v18, s[32:35], s3 offen offset:0 lds
    buffer_load_dwordx4 v19, s[32:35], s3 offen offset:1024 lds
    buffer_load_dwordx4 v20, s[32:35], s3 offen offset:2048 lds
    buffer_load_dwordx4 v21, s[32:35], s3 offen offset:3072 lds
    s_mov_b32 m0, 160228
    s_mov_b64 exec, 1
    global_load_lds_dword v28, s[100:101] offset:28
    s_mov_b64 exec, -1
    s_lshl_b32 s3, s60, 11
    s_nop 0
    s_mov_b32 m0, 161664
    s_add_u32 s3, s3, 65536
    buffer_load_dwordx4 v2, s[52:55], s3 offen offset:0 sc1 lds
    buffer_load_dwordx4 v2, s[52:55], s3 offen offset:1024 sc1 lds
    s_mov_b32 m0, 160364
    s_mov_b64 exec, 1
    global_load_lds_dword v28, s[100:101] offset:4
    s_mov_b64 exec, -1
L_sk_45:
    s_cmp_lg_u32 s66, 1
    s_cbranch_scc1 L_sk_49
    s_setprio 0
    ds_read_b128 v[8:11], v6 offset:16
    s_waitcnt lgkmcnt(0)
    v_min3_u32 v8, v8, v9, v10
    v_min_u32 v8, v8, v11
    v_cmp_gt_u32 vcc, 4, v8
    s_cbranch_vccnz L_fs_50
L_fr_51:
    s_setprio 3
    s_setprio 2
    s_add_u32 s3, s44, 7
    s_and_b32 s3, s3, 7
    s_lshl_b32 s4, s3, 7
    s_add_u32 s4, s4, s45
    s_waitcnt vmcnt(8)
    s_mov_b32 m0, 49152
    s_nop 0
    s_nop 0
    buffer_load_dwordx4 v14, s[8:11], s4 offen offset:0 lds
    buffer_load_dwordx4 v15, s[8:11], s4 offen offset:1024 lds
    buffer_load_dwordx4 v16, s[8:11], s4 offen offset:2048 lds
    buffer_load_dwordx4 v17, s[8:11], s4 offen offset:3072 lds
    s_waitcnt vmcnt(8)
    s_nop 0
    s_mov_b32 m0, 53248
    s_add_u32 s4, s4, 32768
    buffer_load_dwordx4 v14, s[8:11], s4 offen offset:0 lds
    buffer_load_dwordx4 v15, s[8:11], s4 offen offset:1024 lds
    buffer_load_dwordx4 v16, s[8:11], s4 offen offset:2048 lds
    buffer_load_dwordx4 v17, s[8:11], s4 offen offset:3072 lds
    s_waitcnt vmcnt(8)
    s_nop 0
    s_mov_b32 m0, 57344
    s_add_u32 s4, s4, 32768
    buffer_load_dwordx4 v14, s[8:11], s4 offen offset:0 lds
    buffer_load_dwordx4 v15, s[8:11], s4 offen offset:1024 lds
    buffer_load_dwordx4 v16, s[8:11], s4 offen offset:2048 lds
    buffer_load_dwordx4 v17, s[8:11], s4 offen offset:3072 lds
    s_waitcnt vmcnt(8)
    s_nop 0
    s_mov_b32 m0, 61440
    s_add_u32 s4, s4, 32768
    buffer_load_dwordx4 v14, s[8:11], s4 offen offset:0 lds
    buffer_load_dwordx4 v15, s[8:11], s4 offen offset:1024 lds
    buffer_load_dwordx4 v16, s[8:11], s4 offen offset:2048 lds
    buffer_load_dwordx4 v17, s[8:11], s4 offen offset:3072 lds
    s_setprio 3
    s_add_u32 s3, s44, 7
    s_and_b32 s3, s3, 7
    s_mul_i32 s3, s3, 176128
    s_add_u32 s3, s3, s46
    s_waitcnt vmcnt(8)
    s_mov_b32 m0, 114688
    s_nop 0
    buffer_load_dwordx4 v18, s[32:35], s3 offen offset:0 lds
    buffer_load_dwordx4 v19, s[32:35], s3 offen offset:1024 lds
    buffer_load_dwordx4 v20, s[32:35], s3 offen offset:2048 lds
    buffer_load_dwordx4 v21, s[32:35], s3 offen offset:3072 lds
    s_waitcnt vmcnt(8)
    s_nop 0
    s_mov_b32 m0, 118784
    s_add_u32 s3, s3, 44032
    buffer_load_dwordx4 v18, s[32:35], s3 offen offset:0 lds
    buffer_load_dwordx4 v19, s[32:35], s3 offen offset:1024 lds
    buffer_load_dwordx4 v20, s[32:35], s3 offen offset:2048 lds
    buffer_load_dwordx4 v21, s[32:35], s3 offen offset:3072 lds
    s_waitcnt vmcnt(8)
    s_nop 0
    s_mov_b32 m0, 122880
    s_add_u32 s3, s3, 44032
    buffer_load_dwordx4 v18, s[32:35], s3 offen offset:0 lds
    buffer_load_dwordx4 v19, s[32:35], s3 offen offset:1024 lds
    buffer_load_dwordx4 v20, s[32:35], s3 offen offset:2048 lds
    buffer_load_dwordx4 v21, s[32:35], s3 offen offset:3072 lds
    s_waitcnt vmcnt(8)
    s_nop 0
    s_mov_b32 m0, 126976
    s_add_u32 s3, s3, 44032
    buffer_load_dwordx4 v18, s[32:35], s3 offen offset:0 lds
    buffer_load_dwordx4 v19, s[32:35], s3 offen offset:1024 lds
    buffer_load_dwordx4 v20, s[32:35], s3 offen offset:2048 lds
    buffer_load_dwordx4 v21, s[32:35], s3 offen offset:3072 lds
    s_mov_b32 m0, 160228
    s_mov_b64 exec, 1
    global_load_lds_dword v28, s[100:101] offset:32
    s_mov_b64 exec, -1
L_sk_49:
L_lw2:
    s_cmp_lg_u32 s66, 0
    s_cbranch_scc1 L_sk_53
    s_setprio 0
    ds_read_b128 v[8:11], v6 offset:16
    s_waitcnt lgkmcnt(0)
    v_min3_u32 v8, v8, v9, v10
    v_min_u32_e64 v8, v8, v11
    v_cmp_gt_u32 vcc, 7, v8
    s_cbranch_vccnz L_fs_54
L_fr_55:
    s_setprio 3
    s_cmp_lt_u32 0, s67
    s_cselect_b32 s3, s70, s72
    s_mov_b32 m0, 0
    s_add_u32 s3, s3, 0
    s_waitcnt vmcnt(6)
    buffer_load_dwordx4 v22, s[40:43], s3 offen offset:0 lds
    buffer_load_dwordx4 v23, s[40:43], s3 offen offset:1024 lds
    buffer_load_dwordx4 v24, s[40:43], s3 offen offset:2048 lds
    buffer_load_dwordx4 v25, s[40:43], s3 offen offset:3072 lds
    s_cmp_lt_u32 0, s47
    s_cselect_b32 s3, s71, s73
    s_mov_b32 m0, 4096
    s_add_u32 s3, s3, 786432
    s_waitcnt vmcnt(6)
    s_nop 0
    buffer_load_dwordx4 v22, s[40:43], s3 offen offset:0 lds
    buffer_load_dwordx4 v23, s[40:43], s3 offen offset:1024 lds
    buffer_load_dwordx4 v24, s[40:43], s3 offen offset:2048 lds
    buffer_load_dwordx4 v25, s[40:43], s3 offen offset:3072 lds
    s_cmp_lt_u32 1, s67
    s_cselect_b32 s3, s70, s72
    s_mov_b32 m0, 8192
    s_add_u32 s3, s3, 32768
    s_waitcnt vmcnt(6)
    s_nop 0
    buffer_load_dwordx4 v22, s[40:43], s3 offen offset:0 lds
    buffer_load_dwordx4 v23, s[40:43], s3 offen offset:1024 lds
    buffer_load_dwordx4 v24, s[40:43], s3 offen offset:2048 lds
    buffer_load_dwordx4 v25, s[40:43], s3 offen offset:3072 lds
    s_cmp_lt_u32 1, s47
    s_cselect_b32 s3, s71, s73
    s_mov_b32 m0, 12288
    s_add_u32 s3, s3, 819200
    s_waitcnt vmcnt(6)
    s_nop 0
    buffer_load_dwordx4 v22, s[40:43], s3 offen offset:0 lds
    buffer_load_dwordx4 v23, s[40:43], s3 offen offset:1024 lds
    buffer_load_dwordx4 v24, s[40:43], s3 offen offset:2048 lds
    buffer_load_dwordx4 v25, s[40:43], s3 offen offset:3072 lds
    s_cmp_lt_u32 2, s67
    s_cselect_b32 s3, s70, s72
    s_mov_b32 m0, 65536
    s_add_u32 s3, s3, 65536
    s_waitcnt vmcnt(6)
    s_nop 0
    buffer_load_dwordx4 v22, s[40:43], s3 offen offset:0 lds
    buffer_load_dwordx4 v23, s[40:43], s3 offen offset:1024 lds
    buffer_load_dwordx4 v24, s[40:43], s3 offen offset:2048 lds
    buffer_load_dwordx4 v25, s[40:43], s3 offen offset:3072 lds
    s_cmp_lt_u32 2, s47
    s_cselect_b32 s3, s71, s73
    s_mov_b32 m0, 69632
    s_add_u32 s3, s3, 851968
    s_waitcnt vmcnt(6)
    s_nop 0
    buffer_load_dwordx4 v22, s[40:43], s3 offen offset:0 lds
    buffer_load_dwordx4 v23, s[40:43], s3 offen offset:1024 lds
    buffer_load_dwordx4 v24, s[40:43], s3 offen offset:2048 lds
    buffer_load_dwordx4 v25, s[40:43], s3 offen offset:3072 lds
    s_cmp_lt_u32 3, s67
    s_cselect_b32 s3, s70, s72
    s_mov_b32 m0, 73728
    s_add_u32 s3, s3, 98304
    s_waitcnt vmcnt(6)
    s_nop 0
    buffer_load_dwordx4 v22, s[40:43], s3 offen offset:0 lds
    buffer_load_dwordx4 v23, s[40:43], s3 offen offset:1024 lds
    buffer_load_dwordx4 v24, s[40:43], s3 offen offset:2048 lds
    buffer_load_dwordx4 v25, s[40:43], s3 offen offset:3072 lds
    s_cmp_lt_u32 3, s47
    s_cselect_b32 s3, s71, s73
    s_mov_b32 m0, 77824
    s_add_u32 s3, s3, 884736
    s_waitcnt vmcnt(6)
    s_nop 0
    buffer_load_dwordx4 v22, s[40:43], s3 offen offset:0 lds
    buffer_load_dwordx4 v23, s[40:43], s3 offen offset:1024 lds
    buffer_load_dwordx4 v24, s[40:43], s3 offen offset:2048 lds
    buffer_load_dwordx4 v25, s[40:43], s3 offen offset:3072 lds
    s_mov_b32 m0, 160480
    s_mov_b64 exec, 1
    global_load_lds_dword v28, s[100:101] offset:16
    s_mov_b64 exec, -1
L_sk_53:
    s_cmp_lg_u32 s66, 1
    s_cbranch_scc1 L_sk_57
    s_setprio 0
    ds_read_b128 v[8:11], v6 offset:16
    s_waitcnt lgkmcnt(0)
    v_min3_u32 v8, v8, v9, v10
    v_min_u32_e64 v8, v8, v11
    v_cmp_gt_u32 vcc, 7, v8
    s_cbranch_vccnz L_fs_58
L_fr_59:
    s_setprio 3
    s_setprio 0
    ds_read_b128 v[8:11], v6 offset:16
    s_waitcnt lgkmcnt(0)
    v_min3_u32 v8, v8, v9, v10
    v_min_u32 v8, v8, v11
    v_cmp_gt_u32 vcc, 8, v8
    s_cbranch_vccnz L_fs_61
L_fr_62:
    s_setprio 3
    s_cmp_lg_u32 s69, 0
    s_cbranch_scc1 L_nohd
    s_lshl_b32 s3, s59, 18
    s_lshl_b32 s4, s58, 13
    s_add_u32 s3, s3, s4
    s_mov_b32 m0, 124864
    s_add_u32 s3, s3, 4
    s_nop 0
    buffer_load_dwordx4 v2, s[24:27], s3 offen offset:0 lds
    buffer_load_dwordx4 v2, s[24:27], s3 offen offset:1024 lds
    buffer_load_dwordx4 v2, s[24:27], s3 offen offset:2048 lds
    buffer_load_dwordx4 v2, s[24:27], s3 offen offset:3072 lds
    s_mov_b32 m0, 129088
    s_add_u32 s3, s3, 4
    s_nop 0
    buffer_load_dwordx4 v2, s[24:27], s3 offen offset:0 lds
    buffer_load_dwordx4 v2, s[24:27], s3 offen offset:1024 lds
    buffer_load_dwordx4 v2, s[24:27], s3 offen offset:2048 lds
    buffer_load_dwordx4 v2, s[24:27], s3 offen offset:3072 lds
    s_mov_b32 m0, 133312
    s_add_u32 s3, s3, 4092
    buffer_load_dwordx4 v2, s[24:27], s3 offen offset:0 lds
    buffer_load_dwordx4 v2, s[24:27], s3 offen offset:1024 lds
    buffer_load_dwordx4 v2, s[24:27], s3 offen offset:2048 lds
    buffer_load_dwordx4 v2, s[24:27], s3 offen offset:3072 lds
    s_mov_b32 m0, 137536
    s_add_u32 s3, s3, 4
    s_nop 0
    buffer_load_dwordx4 v2, s[24:27], s3 offen offset:0 lds
    buffer_load_dwordx4 v2, s[24:27], s3 offen offset:1024 lds
    buffer_load_dwordx4 v2, s[24:27], s3 offen offset:2048 lds
    buffer_load_dwordx4 v2, s[24:27], s3 offen offset:3072 lds
    s_mov_b32 m0, 160264
    s_mov_b64 exec, 1
    global_load_lds_dword v28, s[100:101] offset:4
    s_mov_b64 exec, -1
L_nohd:
    s_cmp_lt_u32 4, s67
    s_cselect_b32 s3, s70, s72
    s_mov_b32 m0, 16384
    s_add_u32 s3, s3, 131072
    s_waitcnt vmcnt(6)
    s_nop 0
    buffer_load_dwordx4 v22, s[40:43], s3 offen offset:0 lds
    buffer_load_dwordx4 v23, s[40:43], s3 offen offset:1024 lds
    buffer_load_dwordx4 v24, s[40:43], s3 offen offset:2048 lds
    buffer_load_dwordx4 v25, s[40:43], s3 offen offset:3072 lds
    s_cmp_lt_u32 4, s47
    s_cselect_b32 s3, s71, s73
    s_mov_b32 m0, 20480
    s_add_u32 s3, s3, 917504
    s_waitcnt vmcnt(6)
    s_nop 0
    buffer_load_dwordx4 v22, s[40:43], s3 offen offset:0 lds
    buffer_load_dwordx4 v23, s[40:43], s3 offen offset:1024 lds
    buffer_load_dwordx4 v24, s[40:43], s3 offen offset:2048 lds
    buffer_load_dwordx4 v25, s[40:43], s3 offen offset:3072 lds
    s_cmp_lt_u32 5, s67
    s_cselect_b32 s3, s70, s72
    s_mov_b32 m0, 24576
    s_add_u32 s3, s3, 163840
    s_waitcnt vmcnt(6)
    s_nop 0
    buffer_load_dwordx4 v22, s[40:43], s3 offen offset:0 lds
    buffer_load_dwordx4 v23, s[40:43], s3 offen offset:1024 lds
    buffer_load_dwordx4 v24, s[40:43], s3 offen offset:2048 lds
    buffer_load_dwordx4 v25, s[40:43], s3 offen offset:3072 lds
    s_cmp_lt_u32 5, s47
    s_cselect_b32 s3, s71, s73
    s_mov_b32 m0, 28672
    s_add_u32 s3, s3, 950272
    s_waitcnt vmcnt(6)
    s_nop 0
    buffer_load_dwordx4 v22, s[40:43], s3 offen offset:0 lds
    buffer_load_dwordx4 v23, s[40:43], s3 offen offset:1024 lds
    buffer_load_dwordx4 v24, s[40:43], s3 offen offset:2048 lds
    buffer_load_dwordx4 v25, s[40:43], s3 offen offset:3072 lds
    s_cmp_lt_u32 6, s67
    s_cselect_b32 s3, s70, s72
    s_mov_b32 m0, 81920
    s_add_u32 s3, s3, 196608
    s_waitcnt vmcnt(6)
    s_nop 0
    buffer_load_dwordx4 v22, s[40:43], s3 offen offset:0 lds
    buffer_load_dwordx4 v23, s[40:43], s3 offen offset:1024 lds
    buffer_load_dwordx4 v24, s[40:43], s3 offen offset:2048 lds
    buffer_load_dwordx4 v25, s[40:43], s3 offen offset:3072 lds
    s_cmp_lt_u32 6, s47
    s_cselect_b32 s3, s71, s73
    s_mov_b32 m0, 86016
    s_add_u32 s3, s3, 983040
    s_waitcnt vmcnt(6)
    s_nop 0
    buffer_load_dwordx4 v22, s[40:43], s3 offen offset:0 lds
    buffer_load_dwordx4 v23, s[40:43], s3 offen offset:1024 lds
    buffer_load_dwordx4 v24, s[40:43], s3 offen offset:2048 lds
    buffer_load_dwordx4 v25, s[40:43], s3 offen offset:3072 lds
    s_cmp_lt_u32 7, s67
    s_cselect_b32 s3, s70, s72
    s_mov_b32 m0, 90112
    s_add_u32 s3, s3, 229376
    s_waitcnt vmcnt(6)
    s_nop 0
    buffer_load_dwordx4 v22, s[40:43], s3 offen offset:0 lds
    buffer_load_dwordx4 v23, s[40:43], s3 offen offset:1024 lds
    buffer_load_dwordx4 v24, s[40:43], s3 offen offset:2048 lds
    buffer_load_dwordx4 v25, s[40:43], s3 offen offset:3072 lds
    s_cmp_lt_u32 7, s47
    s_cselect_b32 s3, s71, s73
    s_mov_b32 m0, 94208
    s_add_u32 s3, s3, 1015808
    s_waitcnt vmcnt(6)
    s_nop 0
    buffer_load_dwordx4 v22, s[40:43], s3 offen offset:0 lds
    buffer_load_dwordx4 v23, s[40:43], s3 offen offset:1024 lds
    buffer_load_dwordx4 v24, s[40:43], s3 offen offset:2048 lds
    buffer_load_dwordx4 v25, s[40:43], s3 offen offset:3072 lds
    s_mov_b32 m0, 160468
    s_mov_b64 exec, 1
    global_load_lds_dword v28, s[100:101] offset:32
    s_mov_b64 exec, -1
L_sk_57:
    s_cmp_lg_u32 s66, 0
    s_cbranch_scc1 L_sk_64
    s_setprio 0
    ds_read_b128 v[8:11], v6 offset:16
    s_waitcnt lgkmcnt(0)
    v_min3_u32 v8, v8, v9, v10
    v_min_u32 v8, v8, v11
    v_cmp_gt_u32 vcc, 7, v8
    s_cbranch_vccnz L_fs_65
L_fr_66:
    s_setprio 3
    s_cmp_lt_u32 8, s67
    s_cselect_b32 s3, s70, s72
    s_mov_b32 m0, 32768
    s_add_u32 s3, s3, 262144
    s_waitcnt vmcnt(6)
    s_nop 0
    buffer_load_dwordx4 v22, s[40:43], s3 offen offset:0 lds
    buffer_load_dwordx4 v23, s[40:43], s3 offen offset:1024 lds
    buffer_load_dwordx4 v24, s[40:43], s3 offen offset:2048 lds
    buffer_load_dwordx4 v25, s[40:43], s3 offen offset:3072 lds
    s_cmp_lt_u32 8, s47
    s_cselect_b32 s3, s71, s73
    s_mov_b32 m0, 36864
    s_add_u32 s3, s3, 1048576
    s_waitcnt vmcnt(6)
    s_nop 0
    buffer_load_dwordx4 v22, s[40:43], s3 offen offset:0 lds
    buffer_load_dwordx4 v23, s[40:43], s3 offen offset:1024 lds
    buffer_load_dwordx4 v24, s[40:43], s3 offen offset:2048 lds
    buffer_load_dwordx4 v25, s[40:43], s3 offen offset:3072 lds
    s_cmp_lt_u32 9, s67
    s_cselect_b32 s3, s70, s72
    s_mov_b32 m0, 40960
    s_add_u32 s3, s3, 294912
    s_waitcnt vmcnt(6)
    s_nop 0
    buffer_load_dwordx4 v22, s[40:43], s3 offen offset:0 lds
    buffer_load_dwordx4 v23, s[40:43], s3 offen offset:1024 lds
    buffer_load_dwordx4 v24, s[40:43], s3 offen offset:2048 lds
    buffer_load_dwordx4 v25, s[40:43], s3 offen offset:3072 lds
    s_cmp_lt_u32 9, s47
    s_cselect_b32 s3, s71, s73
    s_mov_b32 m0, 45056
    s_add_u32 s3, s3, 1081344
    s_waitcnt vmcnt(6)
    s_nop 0
    buffer_load_dwordx4 v22, s[40:43], s3 offen offset:0 lds
    buffer_load_dwordx4 v23, s[40:43], s3 offen offset:1024 lds
    buffer_load_dwordx4 v24, s[40:43], s3 offen offset:2048 lds
    buffer_load_dwordx4 v25, s[40:43], s3 offen offset:3072 lds
    s_cmp_lt_u32 10, s67
    s_cselect_b32 s3, s70, s72
    s_mov_b32 m0, 98304
    s_add_u32 s3, s3, 327680
    s_waitcnt vmcnt(6)
    s_nop 0
    buffer_load_dwordx4 v22, s[40:43], s3 offen offset:0 lds
    buffer_load_dwordx4 v23, s[40:43], s3 offen offset:1024 lds
    buffer_load_dwordx4 v24, s[40:43], s3 offen offset:2048 lds
    buffer_load_dwordx4 v25, s[40:43], s3 offen offset:3072 lds
    s_cmp_lt_u32 10, s47
    s_cselect_b32 s3, s71, s73
    s_mov_b32 m0, 102400
    s_add_u32 s3, s3, 1114112
    s_waitcnt vmcnt(6)
    s_nop 0
    buffer_load_dwordx4 v22, s[40:43], s3 offen offset:0 lds
    buffer_load_dwordx4 v23, s[40:43], s3 offen offset:1024 lds
    buffer_load_dwordx4 v24, s[40:43], s3 offen offset:2048 lds
    buffer_load_dwordx4 v25, s[40:43], s3 offen offset:3072 lds
    s_cmp_lt_u32 11, s67
    s_cselect_b32 s3, s70, s72
    s_mov_b32 m0, 106496
    s_add_u32 s3, s3, 360448
    s_waitcnt vmcnt(6)
    s_nop 0
    buffer_load_dwordx4 v22, s[40:43], s3 offen offset:0 lds
    buffer_load_dwordx4 v23, s[40:43], s3 offen offset:1024 lds
    buffer_load_dwordx4 v24, s[40:43], s3 offen offset:2048 lds
    buffer_load_dwordx4 v25, s[40:43], s3 offen offset:3072 lds
    s_cmp_lt_u32 11, s47
    s_cselect_b32 s3, s71, s73
    s_mov_b32 m0, 110592
    s_add_u32 s3, s3, 1146880
    s_waitcnt vmcnt(6)
    s_nop 0
    buffer_load_dwordx4 v22, s[40:43], s3 offen offset:0 lds
    buffer_load_dwordx4 v23, s[40:43], s3 offen offset:1024 lds
    buffer_load_dwordx4 v24, s[40:43], s3 offen offset:2048 lds
    buffer_load_dwordx4 v25, s[40:43], s3 offen offset:3072 lds
    s_mov_b32 m0, 160448
    s_mov_b64 exec, 1
    global_load_lds_dword v28, s[100:101] offset:48
    s_mov_b64 exec, -1
L_sk_64:
    s_cmp_lg_u32 s66, 1
    s_cbranch_scc1 L_sk_68
    s_setprio 0
    ds_read_b128 v[8:11], v6 offset:16
    s_waitcnt lgkmcnt(0)
    v_min3_u32 v8, v8, v9, v10
    v_min_u32 v8, v8, v11
    v_cmp_gt_u32 vcc, 8, v8
    s_cbranch_vccnz L_fs_69
L_fr_70:
    s_setprio 3
    s_cmp_lt_u32 12, s67
    s_cselect_b32 s3, s70, s72
    s_mov_b32 m0, 49152
    s_add_u32 s3, s3, 393216
    s_waitcnt vmcnt(6)
    s_nop 0
    buffer_load_dwordx4 v22, s[40:43], s3 offen offset:0 lds
    buffer_load_dwordx4 v23, s[40:43], s3 offen offset:1024 lds
    buffer_load_dwordx4 v24, s[40:43], s3 offen offset:2048 lds
    buffer_load_dwordx4 v25, s[40:43], s3 offen offset:3072 lds
    s_cmp_lt_u32 12, s47
    s_cselect_b32 s3, s71, s73
    s_mov_b32 m0, 53248
    s_add_u32 s3, s3, 1179648
    s_waitcnt vmcnt(6)
    s_nop 0
    buffer_load_dwordx4 v22, s[40:43], s3 offen offset:0 lds
    buffer_load_dwordx4 v23, s[40:43], s3 offen offset:1024 lds
    buffer_load_dwordx4 v24, s[40:43], s3 offen offset:2048 lds
    buffer_load_dwordx4 v25, s[40:43], s3 offen offset:3072 lds
    s_cmp_lt_u32 13, s67
    s_cselect_b32 s3, s70, s72
    s_mov_b32 m0, 57344
    s_add_u32 s3, s3, 425984
    s_waitcnt vmcnt(6)
    s_nop 0
    buffer_load_dwordx4 v22, s[40:43], s3 offen offset:0 lds
    buffer_load_dwordx4 v23, s[40:43], s3 offen offset:1024 lds
    buffer_load_dwordx4 v24, s[40:43], s3 offen offset:2048 lds
    buffer_load_dwordx4 v25, s[40:43], s3 offen offset:3072 lds
    s_cmp_lt_u32 13, s47
    s_cselect_b32 s3, s71, s73
    s_mov_b32 m0, 61440
    s_add_u32 s3, s3, 1212416
    s_waitcnt vmcnt(6)
    s_nop 0
    buffer_load_dwordx4 v22, s[40:43], s3 offen offset:0 lds
    buffer_load_dwordx4 v23, s[40:43], s3 offen offset:1024 lds
    buffer_load_dwordx4 v24, s[40:43], s3 offen offset:2048 lds
    buffer_load_dwordx4 v25, s[40:43], s3 offen offset:3072 lds
    s_cmp_lt_u32 14, s67
    s_cselect_b32 s3, s70, s72
    s_mov_b32 m0, 114688
    s_add_u32 s3, s3, 458752
    s_waitcnt vmcnt(6)
    s_nop 0
    buffer_load_dwordx4 v22, s[40:43], s3 offen offset:0 lds
    buffer_load_dwordx4 v23, s[40:43], s3 offen offset:1024 lds
    buffer_load_dwordx4 v24, s[40:43], s3 offen offset:2048 lds
    buffer_load_dwordx4 v25, s[40:43], s3 offen offset:3072 lds
    s_cmp_lt_u32 14, s47
    s_cselect_b32 s3, s71, s73
    s_mov_b32 m0, 118784
    s_add_u32 s3, s3, 1245184
    s_waitcnt vmcnt(6)
    s_nop 0
    buffer_load_dwordx4 v22, s[40:43], s3 offen offset:0 lds
    buffer_load_dwordx4 v23, s[40:43], s3 offen offset:1024 lds
    buffer_load_dwordx4 v24, s[40:43], s3 offen offset:2048 lds
    buffer_load_dwordx4 v25, s[40:43], s3 offen offset:3072 lds
    s_mov_b32 m0, 160440
    s_mov_b64 exec, 1
    global_load_lds_dword v28, s[100:101] offset:60
    s_mov_b64 exec, -1
L_sk_68:
    s_cmp_lg_u32 s66, 0
    s_cbranch_scc1 L_sk_72
    s_setprio 0
    ds_read_b128 v[8:11], v6 offset:128
    s_waitcnt lgkmcnt(0)
    v_min3_u32 v8, v8, v9, v10
    v_min_u32_e64 v8, v8, v11
    v_cmp_gt_u32 vcc, 4, v8
    s_cbranch_vccnz L_fs_73
L_fr_74:
    s_setprio 3
    s_cmp_lt_u32 15, s67
    s_cselect_b32 s3, s70, s72
    s_mov_b32 m0, 0
    s_add_u32 s3, s3, 491520
    s_waitcnt vmcnt(40)
    s_nop 0
    buffer_load_dwordx4 v22, s[40:43], s3 offen offset:0 lds
    buffer_load_dwordx4 v23, s[40:43], s3 offen offset:1024 lds
    buffer_load_dwordx4 v24, s[40:43], s3 offen offset:2048 lds
    buffer_load_dwordx4 v25, s[40:43], s3 offen offset:3072 lds
    s_cmp_lt_u32 16, s67
    s_cselect_b32 s3, s70, s72
    s_mov_b32 m0, 8192
    s_add_u32 s3, s3, 524288
    s_waitcnt vmcnt(40)
    s_nop 0
    buffer_load_dwordx4 v22, s[40:43], s3 offen offset:0 lds
    buffer_load_dwordx4 v23, s[40:43], s3 offen offset:1024 lds
    buffer_load_dwordx4 v24, s[40:43], s3 offen offset:2048 lds
    buffer_load_dwordx4 v25, s[40:43], s3 offen offset:3072 lds
    s_cmp_lt_u32 17, s67
    s_cselect_b32 s3, s70, s72
    s_mov_b32 m0, 65536
    s_add_u32 s3, s3, 557056
    s_waitcnt vmcnt(40)
    s_nop 0
    buffer_load_dwordx4 v22, s[40:43], s3 offen offset:0 lds
    buffer_load_dwordx4 v23, s[40:43], s3 offen offset:1024 lds
    buffer_load_dwordx4 v24, s[40:43], s3 offen offset:2048 lds
    buffer_load_dwordx4 v25, s[40:43], s3 offen offset:3072 lds
    s_cmp_lt_u32 18, s67
    s_cselect_b32 s3, s70, s72
    s_mov_b32 m0, 73728
    s_add_u32 s3, s3, 589824
    s_waitcnt vmcnt(40)
    s_nop 0
    buffer_load_dwordx4 v22, s[40:43], s3 offen offset:0 lds
    buffer_load_dwordx4 v23, s[40:43], s3 offen offset:1024 lds
    buffer_load_dwordx4 v24, s[40:43], s3 offen offset:2048 lds
    buffer_load_dwordx4 v25, s[40:43], s3 offen offset:3072 lds
    s_mov_b32 m0, 160420
    s_mov_b64 exec, 1
    global_load_lds_dword v28, s[100:101] offset:76
    s_mov_b64 exec, -1
    s_setprio 0
    ds_read_b128 v[8:11], v6 offset:128
    s_waitcnt lgkmcnt(0)
    v_min3_u32 v8, v8, v9, v10
    v_min_u32 v8, v8, v11
    v_cmp_gt_u32 vcc, 9, v8
    s_cbranch_vccnz L_fs_76
L_fr_77:
    s_setprio 3
    s_cmp_lt_u32 19, s67
    s_cselect_b32 s3, s70, s72
    s_mov_b32 m0, 16384
    s_add_u32 s3, s3, 622592
    s_waitcnt vmcnt(40)
    s_nop 0
    buffer_load_dwordx4 v22, s[40:43], s3 offen offset:0 lds
    buffer_load_dwordx4 v23, s[40:43], s3 offen offset:1024 lds
    buffer_load_dwordx4 v24, s[40:43], s3 offen offset:2048 lds
    buffer_load_dwordx4 v25, s[40:43], s3 offen offset:3072 lds
    s_cmp_lt_u32 20, s67
    s_cselect_b32 s3, s70, s72
    s_mov_b32 m0, 24576
    s_add_u32 s3, s3, 655360
    s_waitcnt vmcnt(40)
    s_nop 0
    buffer_load_dwordx4 v22, s[40:43], s3 offen offset:0 lds
    buffer_load_dwordx4 v23, s[40:43], s3 offen offset:1024 lds
    buffer_load_dwordx4 v24, s[40:43], s3 offen offset:2048 lds
    buffer_load_dwordx4 v25, s[40:43], s3 offen offset:3072 lds
    s_cmp_lt_u32 21, s67
    s_cselect_b32 s3, s70, s72
    s_mov_b32 m0, 81920
    s_add_u32 s3, s3, 688128
    s_waitcnt vmcnt(40)
    s_nop 0
    buffer_load_dwordx4 v22, s[40:43], s3 offen offset:0 lds
    buffer_load_dwordx4 v23, s[40:43], s3 offen offset:1024 lds
    buffer_load_dwordx4 v24, s[40:43], s3 offen offset:2048 lds
    buffer_load_dwordx4 v25, s[40:43], s3 offen offset:3072 lds
    s_cmp_lt_u32 22, s67
    s_cselect_b32 s3, s70, s72
    s_mov_b32 m0, 90112
    s_add_u32 s3, s3, 720896
    s_waitcnt vmcnt(40)
    s_nop 0
    buffer_load_dwordx4 v22, s[40:43], s3 offen offset:0 lds
    buffer_load_dwordx4 v23, s[40:43], s3 offen offset:1024 lds
    buffer_load_dwordx4 v24, s[40:43], s3 offen offset:2048 lds
    buffer_load_dwordx4 v25, s[40:43], s3 offen offset:3072 lds
    s_cmp_lt_u32 23, s67
    s_cselect_b32 s3, s70, s72
    s_mov_b32 m0, 32768
    s_add_u32 s3, s3, 753664
    s_waitcnt vmcnt(40)
    s_nop 0
    buffer_load_dwordx4 v22, s[40:43], s3 offen offset:0 lds
    buffer_load_dwordx4 v23, s[40:43], s3 offen offset:1024 lds
    buffer_load_dwordx4 v24, s[40:43], s3 offen offset:2048 lds
    buffer_load_dwordx4 v25, s[40:43], s3 offen offset:3072 lds
    s_mov_b32 m0, 160400
    s_mov_b64 exec, 1
    global_load_lds_dword v28, s[100:101] offset:96
    s_mov_b64 exec, -1
    s_branch L_ldone
L_sk_72:
    s_setprio 0
    ds_read_b128 v[8:11], v6 offset:144
    s_waitcnt lgkmcnt(0)
    v_min3_u32 v8, v8, v9, v10
    v_min_u32_e64 v8, v8, v11
    v_cmp_gt_u32 vcc, 4, v8
    s_cbranch_vccnz L_fs_79
L_fr_80:
    s_setprio 3
    s_cmp_lt_u32 15, s47
    s_cselect_b32 s3, s71, s73
    s_mov_b32 m0, 4096
    s_add_u32 s3, s3, 1277952
    s_waitcnt vmcnt(40)
    s_nop 0
    buffer_load_dwordx4 v22, s[40:43], s3 offen offset:0 lds
    buffer_load_dwordx4 v23, s[40:43], s3 offen offset:1024 lds
    buffer_load_dwordx4 v24, s[40:43], s3 offen offset:2048 lds
    buffer_load_dwordx4 v25, s[40:43], s3 offen offset:3072 lds
    s_cmp_lt_u32 16, s47
    s_cselect_b32 s3, s71, s73
    s_mov_b32 m0, 12288
    s_add_u32 s3, s3, 1310720
    s_waitcnt vmcnt(40)
    s_nop 0
    buffer_load_dwordx4 v22, s[40:43], s3 offen offset:0 lds
    buffer_load_dwordx4 v23, s[40:43], s3 offen offset:1024 lds
    buffer_load_dwordx4 v24, s[40:43], s3 offen offset:2048 lds
    buffer_load_dwordx4 v25, s[40:43], s3 offen offset:3072 lds
    s_cmp_lt_u32 17, s47
    s_cselect_b32 s3, s71, s73
    s_mov_b32 m0, 69632
    s_add_u32 s3, s3, 1343488
    s_waitcnt vmcnt(40)
    s_nop 0
    buffer_load_dwordx4 v22, s[40:43], s3 offen offset:0 lds
    buffer_load_dwordx4 v23, s[40:43], s3 offen offset:1024 lds
    buffer_load_dwordx4 v24, s[40:43], s3 offen offset:2048 lds
    buffer_load_dwordx4 v25, s[40:43], s3 offen offset:3072 lds
    s_cmp_lt_u32 18, s47
    s_cselect_b32 s3, s71, s73
    s_mov_b32 m0, 77824
    s_add_u32 s3, s3, 1376256
    s_waitcnt vmcnt(40)
    s_nop 0
    buffer_load_dwordx4 v22, s[40:43], s3 offen offset:0 lds
    buffer_load_dwordx4 v23, s[40:43], s3 offen offset:1024 lds
    buffer_load_dwordx4 v24, s[40:43], s3 offen offset:2048 lds
    buffer_load_dwordx4 v25, s[40:43], s3 offen offset:3072 lds
    s_mov_b32 m0, 160424
    s_mov_b64 exec, 1
    global_load_lds_dword v28, s[100:101] offset:76
    s_mov_b64 exec, -1
    s_lshl_b32 s5, s59, 5
    s_add_u32 s5, s5, s58
    s_lshl_b32 s5, s5, 8
    s_add_u32 s5, s5, 262144
    v_lshrrev_b32 v26, 3, v1
    v_lshlrev_b32 v26, 12, v26
    v_and_b32 v27, 7, v1
    v_lshl_add_u32 v14, v27, 4, v26
    v_add_u32 v15, 31744, v14
    v_add_u32 v16, 63488, v14
    v_add_u32 v17, 95232, v14
    s_setprio 0
    ds_read_b128 v[8:11], v6 offset:160
    s_waitcnt lgkmcnt(0)
    v_min3_u32 v8, v8, v9, v10
    v_min_u32_e64 v8, v8, v11
    v_cmp_gt_u32 vcc, 1, v8
    s_cbranch_vccnz L_fs_82
L_fr_83:
    ds_read_b128 v[8:11], v6 offset:128
    s_waitcnt lgkmcnt(0)
    v_min3_u32 v8, v8, v9, v10
    v_min_u32 v8, v8, v11
    v_cmp_gt_u32 vcc, 8, v8
    s_cbranch_vccnz L_fs_85
L_fr_86:
    s_mov_b32 s7, 32768
L_yp:
    s_load_dwordx16 s[8:23], s[52:53], s5 glc
    s_load_dwordx16 s[24:39], s[52:53], s5 offset:64 glc
    s_load_dwordx16 s[72:87], s[52:53], s5 offset:128 glc
    s_load_dwordx8 s[40:47], s[52:53], s5 offset:192 glc
    s_load_dwordx8 s[88:95], s[52:53], s5 offset:224 glc
    s_waitcnt lgkmcnt(0)
    s_xor_b64 s[8:9], s[8:9], s[56:57]
    s_xor_b64 s[10:11], s[10:11], s[56:57]
    s_xor_b64 s[12:13], s[12:13], s[56:57]
    s_xor_b64 s[14:15], s[14:15], s[56:57]
    s_xor_b64 s[16:17], s[16:17], s[56:57]
    s_xor_b64 s[18:19], s[18:19], s[56:57]
    s_xor_b64 s[20:21], s[20:21], s[56:57]
    s_xor_b64 s[22:23], s[22:23], s[56:57]
    s_xor_b64 s[24:25], s[24:25], s[56:57]
    s_xor_b64 s[26:27], s[26:27], s[56:57]
    s_xor_b64 s[28:29], s[28:29], s[56:57]
    s_xor_b64 s[30:31], s[30:31], s[56:57]
    s_xor_b64 s[32:33], s[32:33], s[56:57]
    s_xor_b64 s[34:35], s[34:35], s[56:57]
    s_xor_b64 s[36:37], s[36:37], s[56:57]
    s_xor_b64 s[38:39], s[38:39], s[56:57]
    s_xor_b64 s[72:73], s[72:73], s[56:57]
    s_xor_b64 s[74:75], s[74:75], s[56:57]
    s_xor_b64 s[76:77], s[76:77], s[56:57]
    s_xor_b64 s[78:79], s[78:79], s[56:57]
    s_xor_b64 s[80:81], s[80:81], s[56:57]
    s_xor_b64 s[82:83], s[82:83], s[56:57]
    s_xor_b64 s[84:85], s[84:85], s[56:57]
    s_xor_b64 s[86:87], s[86:87], s[56:57]
    s_xor_b64 s[40:41], s[40:41], s[56:57]
    s_xor_b64 s[42:43], s[42:43], s[56:57]
    s_xor_b64 s[44:45], s[44:45], s[56:57]
    s_xor_b64 s[46:47], s[46:47], s[56:57]
    s_xor_b64 s[88:89], s[88:89], s[56:57]
    s_xor_b64 s[90:91], s[90:91], s[56:57]
    s_xor_b64 s[92:93], s[92:93], s[56:57]
    s_xor_b64 s[94:95], s[94:95], s[56:57]
    s_or_b64 s[8:9], s[8:9], s[10:11]
    s_or_b64 s[8:9], s[8:9], s[12:13]
    s_or_b64 s[8:9], s[8:9], s[14:15]
    s_or_b64 s[8:9], s[8:9], s[16:17]
    s_or_b64 s[8:9], s[8:9], s[18:19]
    s_or_b64 s[8:9], s[8:9], s[20:21]
    s_or_b64 s[8:9], s[8:9], s[22:23]
    s_or_b64 s[8:9], s[8:9], s[24:25]
    s_or_b64 s[8:9], s[8:9], s[26:27]
    s_or_b64 s[8:9], s[8:9], s[28:29]
    s_or_b64 s[8:9], s[8:9], s[30:31]
    s_or_b64 s[8:9], s[8:9], s[32:33]
    s_or_b64 s[8:9], s[8:9], s[34:35]
    s_or_b64 s[8:9], s[8:9], s[36:37]
    s_or_b64 s[8:9], s[8:9], s[38:39]
    s_or_b64 s[8:9], s[8:9], s[72:73]
    s_or_b64 s[8:9], s[8:9], s[74:75]
    s_or_b64 s[8:9], s[8:9], s[76:77]
    s_or_b64 s[8:9], s[8:9], s[78:79]
    s_or_b64 s[8:9], s[8:9], s[80:81]
    s_or_b64 s[8:9], s[8:9], s[82:83]
    s_or_b64 s[8:9], s[8:9], s[84:85]
    s_or_b64 s[8:9], s[8:9], s[86:87]
    s_or_b64 s[8:9], s[8:9], s[40:41]
    s_or_b64 s[8:9], s[8:9], s[42:43]
    s_or_b64 s[8:9], s[8:9], s[44:45]
    s_or_b64 s[8:9], s[8:9], s[46:47]
    s_or_b64 s[8:9], s[8:9], s[88:89]
    s_or_b64 s[8:9], s[8:9], s[90:91]
    s_or_b64 s[8:9], s[8:9], s[92:93]
    s_or_b64 s[8:9], s[8:9], s[94:95]
    s_cbranch_scc0 L_ypok
    s_sleep 2
    s_sub_u32 s7, s7, 1
    s_cbranch_scc0 L_yp
L_ypok:
    s_setprio 3
    s_lshl_b32 s3, s59, 18
    s_lshl_b32 s4, s58, 7
    s_add_u32 s3, s3, s4
    s_mov_b32 m0, 124800
    s_add_u32 s3, s3, 1048576
    buffer_load_dwordx4 v14, s[52:55], s3 offen offset:0 sc1 lds
    buffer_load_dwordx4 v15, s[52:55], s3 offen offset:1024 sc1 lds
    buffer_load_dwordx4 v16, s[52:55], s3 offen offset:2048 sc1 lds
    buffer_load_dwordx4 v17, s[52:55], s3 offen offset:3072 sc1 lds
    s_mov_b32 m0, 128896
    s_add_u32 s3, s3, 131072
    buffer_load_dwordx4 v14, s[52:55], s3 offen offset:0 sc1 lds
    buffer_load_dwordx4 v15, s[52:55], s3 offen offset:1024 sc1 lds
    buffer_load_dwordx4 v16, s[52:55], s3 offen offset:2048 sc1 lds
    buffer_load_dwordx4 v17, s[52:55], s3 offen offset:3072 sc1 lds
    s_mov_b32 m0, 160368
    s_mov_b64 exec, 1
    global_load_lds_dword v28, s[100:101] offset:4
    s_mov_b64 exec, -1
L_ldone:
    s_waitcnt vmcnt(0) lgkmcnt(0)
    s_endpgm
L_fs_23:
L_fl_25:
    s_sleep 1
    ds_read_b32 v8, v6 offset:8
    s_waitcnt lgkmcnt(0)
    v_cmp_gt_u32 vcc, 1, v8
    s_cbranch_vccnz L_fl_25
    s_branch L_fr_24
L_fs_26:
L_fl_28:
    s_sleep 1
    ds_read_b128 v[8:11], v6 offset:32
    s_waitcnt lgkmcnt(0)
    v_min3_u32 v8, v8, v9, v10
    v_min_u32 v8, v8, v11
    v_cmp_gt_u32 vcc, 2, v8
    s_cbranch_vccnz L_fl_28
    s_branch L_fr_27
L_fs_29:
L_fl_31:
    s_sleep 1
    ds_read_b128 v[8:11], v6 offset:48
    s_waitcnt lgkmcnt(0)
    v_min3_u32 v8, v8, v9, v10
    v_min_u32 v8, v8, v11
    v_cmp_gt_u32 vcc, 2, v8
    s_cbranch_vccnz L_fl_31
    s_branch L_fr_30
L_fs_38:
L_fl_40:
    s_sleep 1
    ds_read_b128 v[8:11], v6 offset:16
    s_waitcnt lgkmcnt(0)
    v_min3_u32 v8, v8, v9, v10
    v_min_u32 v8, v8, v11
    v_cmp_gt_u32 vcc, 1, v8
    s_cbranch_vccnz L_fl_40
    s_branch L_fr_39
L_fs_42:
L_fl_44:
    s_sleep 1
    ds_read_b128 v[8:11], v6 offset:16
    s_waitcnt lgkmcnt(0)
    v_min3_u32 v8, v8, v9, v10
    v_min_u32 v8, v8, v11
    v_cmp_gt_u32 vcc, 2, v8
    s_cbranch_vccnz L_fl_44
    s_branch L_fr_43
L_fs_46:
L_fl_48:
    s_sleep 1
    ds_read_b128 v[8:11], v6 offset:16
    s_waitcnt lgkmcnt(0)
    v_min3_u32 v8, v8, v9, v10
    v_min_u32 v8, v8, v11
    v_cmp_gt_u32 vcc, 3, v8
    s_cbranch_vccnz L_fl_48
    s_branch L_fr_47
L_fs_50:
L_fl_52:
    s_sleep 1
    ds_read_b128 v[8:11], v6 offset:16
    s_waitcnt lgkmcnt(0)
    v_min3_u32 v8, v8, v9, v10
    v_min_u32 v8, v8, v11
    v_cmp_gt_u32 vcc, 4, v8
    s_cbranch_vccnz L_fl_52
    s_branch L_fr_51
L_fs_54:
L_fl_56:
    s_sleep 1
    ds_read_b128 v[8:11], v6 offset:16
    s_waitcnt lgkmcnt(0)
    v_min3_u32 v8, v8, v9, v10
    v_min_u32 v8, v8, v11
    v_cmp_gt_u32 vcc, 7, v8
    s_cbranch_vccnz L_fl_56
    s_branch L_fr_55
L_fs_58:
L_fl_60:
    s_sleep 1
    ds_read_b128 v[8:11], v6 offset:16
    s_waitcnt lgkmcnt(0)
    v_min3_u32 v8, v8, v9, v10
    v_min_u32 v8, v8, v11
    v_cmp_gt_u32 vcc, 7, v8
    s_cbranch_vccnz L_fl_60
    s_branch L_fr_59
L_fs_61:
L_fl_63:
    s_sleep 1
    ds_read_b128 v[8:11], v6 offset:16
    s_waitcnt lgkmcnt(0)
    v_min3_u32 v8, v8, v9, v10
    v_min_u32 v8, v8, v11
    v_cmp_gt_u32 vcc, 8, v8
    s_cbranch_vccnz L_fl_63
    s_branch L_fr_62
L_fs_65:
L_fl_67:
    s_sleep 1
    ds_read_b128 v[8:11], v6 offset:16
    s_waitcnt lgkmcnt(0)
    v_min3_u32 v8, v8, v9, v10
    v_min_u32 v8, v8, v11
    v_cmp_gt_u32 vcc, 7, v8
    s_cbranch_vccnz L_fl_67
    s_branch L_fr_66
L_fs_69:
L_fl_71:
    s_sleep 1
    ds_read_b128 v[8:11], v6 offset:16
    s_waitcnt lgkmcnt(0)
    v_min3_u32 v8, v8, v9, v10
    v_min_u32 v8, v8, v11
    v_cmp_gt_u32 vcc, 8, v8
    s_cbranch_vccnz L_fl_71
    s_branch L_fr_70
L_fs_73:
L_fl_75:
    s_sleep 1
    ds_read_b128 v[8:11], v6 offset:128
    s_waitcnt lgkmcnt(0)
    v_min3_u32 v8, v8, v9, v10
    v_min_u32 v8, v8, v11
    v_cmp_gt_u32 vcc, 4, v8
    s_cbranch_vccnz L_fl_75
    s_branch L_fr_74
L_fs_76:
L_fl_78:
    s_sleep 1
    ds_read_b128 v[8:11], v6 offset:128
    s_waitcnt lgkmcnt(0)
    v_min3_u32 v8, v8, v9, v10
    v_min_u32 v8, v8, v11
    v_cmp_gt_u32 vcc, 9, v8
    s_cbranch_vccnz L_fl_78
    s_branch L_fr_77
L_fs_79:
L_fl_81:
    s_sleep 1
    ds_read_b128 v[8:11], v6 offset:144
    s_waitcnt lgkmcnt(0)
    v_min3_u32 v8, v8, v9, v10
    v_min_u32 v8, v8, v11
    v_cmp_gt_u32 vcc, 4, v8
    s_cbranch_vccnz L_fl_81
    s_branch L_fr_80
L_fs_82:
L_fl_84:
    s_sleep 1
    ds_read_b128 v[8:11], v6 offset:160
    s_waitcnt lgkmcnt(0)
    v_min3_u32 v8, v8, v9, v10
    v_min_u32 v8, v8, v11
    v_cmp_gt_u32 vcc, 1, v8
    s_cbranch_vccnz L_fl_84
    s_branch L_fr_83
L_fs_85:
L_fl_87:
    s_sleep 1
    ds_read_b128 v[8:11], v6 offset:128
    s_waitcnt lgkmcnt(0)
    v_min3_u32 v8, v8, v9, v10
    v_min_u32 v8, v8, v11
    v_cmp_gt_u32 vcc, 8, v8
    s_cbranch_vccnz L_fl_87
    s_branch L_fr_86
L_mainB:
    v_mov_b32 v62, 0
    v_mov_b32 v63, 0
    v_mov_b32 v64, 0
    v_mov_b32_e64 v65, 0
    s_mul_i32 s3, s65, 4640
    s_add_u32 s3, s3, 145792
    v_min_u32 v58, 432, v2
    v_add_u32_e64 v58, s3, v58
    ds_write_b128 v58, v[62:65]
    s_lshr_b32 s39, s65, 1
    s_and_b32 s40, s65, 1
    s_lshl_b32 s38, s59, 6
    s_lshl_b32 s3, s58, 1
    s_add_u32 s38, s38, s3
    s_add_u32 s38, s38, s39
    v_and_b32 v58, 15, v1
    v_lshlrev_b32 v58, 2, v58
    s_lshl_b32 s3, s40, 2
    s_sub_u32 s3, s3, 60
    v_add_u32_e64 v61, s3, v58
    s_mul_i32 s4, s65, 4224
    s_add_u32 s4, s4, 124800
    v_add_u32 v62, s4, v58
    s_lshl_b32 s41, s59, 5
    s_add_u32 s41, s41, s58
    s_lshl_b32 s41, s41, 7
    s_add_u32 s41, s41, 131072
    s_lshl_b32 s42, s38, 12
    s_lshl_b32 s3, s40, 11
    s_add_u32 s42, s42, s3
    s_nop 0
    s_add_u32 s43, s42, 1048576
    s_add_u32 s42, s42, 1048576
    s_mul_i32 s3, s39, 8448
    s_add_u32 s3, s3, 124800
    s_lshl_b32 s5, s40, 8
    s_lshl_b32 s6, s40, 12
    s_add_u32 s6, s6, s3
    v_add_u32 v71, s6, v2
    s_xor_b32 s6, s40, 1
    s_lshl_b32 s6, s6, 12
    s_add_u32 s6, s6, s3
    v_add_u32 v72, s6, v2
    s_add_u32 s3, s3, s5
    v_and_b32 v58, 1, v1
    v_mul_u32_u24 v63, 4224, v58
    v_bfe_u32 v64, v1, 1, 3
    v_lshrrev_b32_e64 v59, 4, v1
    v_lshl_add_u32 v63, v64, 3, v63
    v_lshl_add_u32 v63, v59, 4, v63
    v_add_u32_e64 v63, s3, v63
    s_mul_i32 s3, s39, 9280
    s_add_u32 s3, s3, 141696
    s_lshl_b32 s6, s40, 11
    s_add_u32 s4, s3, s6
    v_add_u32 v65, s4, v2
    v_xor_b32 v60, 1, v58
    v_mul_u32_u24 v60, 4640, v60
    v_add_u32 v60, s3, v60
    v_lshlrev_b32 v64, 6, v64
    v_lshl_add_u32 v67, v59, 4, v64
    v_sub_u32_e64 v66, v60, v67
    s_sub_u32 s4, 2544, s6
    v_add_u32 v66, s4, v66
    v_sub_u32 v64, v60, v64
    v_lshl_add_u32 v64, v59, 4, v64
    s_add_u32 s5, s5, 448
    v_add_u32_e64 v64, s5, v64
    v_lshl_add_u32 v67, v58, 9, v67
    s_mov_b32 vcc_lo, 0xaaaaaaaa
    s_mov_b32 vcc_hi, 0xaaaaaaaa
    v_mov_b32 v68, 0x05040100
    v_mov_b32 v58, 0x01000504
    v_cndmask_b32 v68, v68, v58, vcc
    v_add_u32 v69, 0x02020202, v68
    s_lshl_b32 s3, s73, 16
    s_and_b32 s4, s73, 0xffff0000
    s_cmp_eq_u32 s39, 0
    s_cselect_b32 s70, s3, s4
    s_mov_b32 s71, s70
    v_xor_b32 v70, 4, v7
    v_lshlrev_b32 v13, 8, v1
    v_cmp_gt_u32 vcc, 16, v1
    v_mov_b32 v58, 0xffffff00
    s_nop 0
    v_cndmask_b32 v13, v58, v13, vcc
    s_lshl_b32 s3, s59, 13
    s_and_b32 s4, s38, 63
    s_lshl_b32 s4, s4, 2
    s_add_u32 s3, s3, s4
    s_lshl_b32 s4, s40, 12
    s_add_u32 s3, s3, s4
    s_add_u32 s100, s3, 262144
    s_lshl_b32 s3, s58, 1
    s_lshr_b32 s4, s65, 1
    s_add_u32 s3, s3, s4
    s_lshl_b32 s3, s3, 3
    s_add_u32 s3, s3, s59
    s_lshl_b32 s31, s3, 7
    s_add_u32 s31, s31, 196608
    s_lshl_b32 s3, s58, 2
    s_add_u32 s3, s3, s65
    s_mul_i32 s3, s3, 43
    s_mul_i32 s4, s66, 24
    s_add_u32 s3, s3, s4
    s_add_u32 s3, s3, s68
    s_lshl_b32 s28, s3, 10
    s_add_u32 s28, s28, 5242880
    s_add_u32 s4, s68, s67
    s_lshl_b32 s4, s4, 10
    s_sub_u32 s29, s28, s4
    v_bfe_u32 v73, v1, 2, 3
    v_lshrrev_b32_e64 v74, 5, v1
    v_lshl_add_u32 v74, v74, 4, v73
    v_lshlrev_b32 v74, 7, v74
    v_and_b32 v75, 3, v1
    v_lshl_add_u32 v74, v75, 3, v74
    s_lshl_b32 s3, s66, 12
    v_add_u32 v74, s3, v74
    v_lshrrev_b32 v73, 1, v73
    s_lshl_b32 s3, s66, 1
    v_xor_b32 v73, s3, v73
    v_xor_b32 v14, 0, v73
    v_lshl_add_u32 v14, v14, 5, v74
    v_add_u32 v18, 57344, v14
    v_add_u32 v22, 114688, v14
    v_xor_b32_e64 v15, 1, v73
    v_lshl_add_u32 v15, v15, 5, v74
    v_add_u32 v19, 57344, v15
    v_add_u32 v23, 114688, v15
    v_xor_b32_e64 v16, 2, v73
    v_lshl_add_u32 v16, v16, 5, v74
    v_add_u32 v20, 57344, v16
    v_add_u32 v24, 114688, v16
    v_xor_b32_e64 v17, 3, v73
    v_lshl_add_u32 v17, v17, 5, v74
    v_add_u32 v21, 57344, v17
    v_add_u32 v25, 114688, v17
    v_bfe_u32 v89, v1, 4, 1
    v_lshrrev_b32 v74, 5, v1
    v_lshlrev_b32 v89, 5, v89
    v_lshl_add_u32 v89, v74, 4, v89
    v_and_b32_e64 v74, 15, v1
    v_lshl_add_u32 v50, v74, 10, v89
    v_lshlrev_b32_e64 v88, 4, v74
    s_lshl_b32 s3, s58, 2
    s_add_u32 s3, s3, s65
    s_lshl_b32 s34, s59, 7
    s_lshl_b32 s5, s66, 6
    s_add_u32 s34, s34, s5
    s_lshl_b32 s32, s3, 14
    s_add_u32 s32, s32, s34
    s_lshl_b32 s3, s3, 8
    s_add_u32 s33, s3, 65536
    v_lshlrev_b32_e64 v51, 6, v89
    v_bfe_u32 v75, v1, 2, 2
    v_lshl_add_u32 v51, v75, 7, v51
    v_and_b32_e64 v75, 3, v1
    v_lshl_add_u32 v51, v75, 3, v51
    s_lshl_b32 s3, s66, 12
    s_lshl_b32 s5, s65, 5
    s_add_u32 s3, s3, s5
    s_add_u32 s3, s3, 124800
    v_add_u32_e64 v51, s3, v51
    s_lshl_b32 s3, s62, 11
    s_add_u32 s3, s3, 139264
    v_add_u32_e64 v52, s3, v2
    s_xor_b32 s3, s62, 4
    s_lshl_b32 s3, s3, 11
    s_add_u32 s3, s3, 139264
    v_add_u32 v53, s3, v2
    s_lshl_b32 s3, s66, 4
    v_add_u32 v54, s3, v7
    v_xor_b32 v56, 16, v54
    s_lshl_b32 s3, s66, 2
    v_add_u32 v55, s3, v6
    s_lshr_b32 s3, s65, 1
    s_lshl_b32 s3, s3, 2
    v_add_u32_e64 v57, s3, v6
    s_mov_b32 s26, 0x200000
    s_mov_b32 s27, 0x20000
    ds_read_b32 v8, v6 offset:0
    s_waitcnt lgkmcnt(0)
    v_cmp_gt_u32 vcc, 5, v8
    s_cbranch_vccnz L_fs_88
L_fr_89:
    s_mov_b64 s[36:37], s[24:25]
    s_cmp_lg_u32 s65, 0
    s_cbranch_scc1 L_nf0
    s_mov_b32 s7, 32768
L_sp_91:
    s_load_dwordx16 s[12:27], s[52:53], s41 glc
    s_waitcnt lgkmcnt(0)
    s_xor_b64 s[12:13], s[12:13], s[56:57]
    s_xor_b64 s[14:15], s[14:15], s[56:57]
    s_xor_b64 s[16:17], s[16:17], s[56:57]
    s_xor_b64 s[18:19], s[18:19], s[56:57]
    s_xor_b64 s[20:21], s[20:21], s[56:57]
    s_xor_b64 s[22:23], s[22:23], s[56:57]
    s_xor_b64 s[24:25], s[24:25], s[56:57]
    s_xor_b64 s[26:27], s[26:27], s[56:57]
    s_or_b64 s[12:13], s[12:13], s[14:15]
    s_or_b64 s[12:13], s[12:13], s[16:17]
    s_or_b64 s[12:13], s[12:13], s[18:19]
    s_or_b64 s[12:13], s[12:13], s[20:21]
    s_or_b64 s[12:13], s[12:13], s[22:23]
    s_or_b64 s[12:13], s[12:13], s[24:25]
    s_or_b64 s[12:13], s[12:13], s[26:27]
    s_cbranch_scc0 L_spok_92
    s_sleep 3
    s_sub_u32 s7, s7, 1
    s_cbranch_scc0 L_sp_91
L_spok_92:
    s_add_u32 s41, s41, 64
    s_mov_b32 s7, 32768
L_sp_93:
    s_load_dwordx16 s[12:27], s[52:53], s41 glc
    s_waitcnt lgkmcnt(0)
    s_xor_b64 s[12:13], s[12:13], s[56:57]
    s_xor_b64 s[14:15], s[14:15], s[56:57]
    s_xor_b64 s[16:17], s[16:17], s[56:57]
    s_xor_b64 s[18:19], s[18:19], s[56:57]
    s_xor_b64 s[20:21], s[20:21], s[56:57]
    s_xor_b64 s[22:23], s[22:23], s[56:57]
    s_xor_b64 s[24:25], s[24:25], s[56:57]
    s_xor_b64 s[26:27], s[26:27], s[56:57]
    s_or_b64 s[12:13], s[12:13], s[14:15]
    s_or_b64 s[12:13], s[12:13], s[16:17]
    s_or_b64 s[12:13], s[12:13], s[18:19]
    s_or_b64 s[12:13], s[12:13], s[20:21]
    s_or_b64 s[12:13], s[12:13], s[22:23]
    s_or_b64 s[12:13], s[12:13], s[24:25]
    s_or_b64 s[12:13], s[12:13], s[26:27]
    s_cbranch_scc0 L_spok_94
    s_sleep 3
    s_sub_u32 s7, s7, 1
    s_cbranch_scc0 L_sp_93
L_spok_94:
    v_mov_b32 v12, 1
    ds_write_b32 v6, v12 offset:192
L_nf0:
    ds_read_b32 v8, v6 offset:192
    s_waitcnt lgkmcnt(0)
    v_cmp_gt_u32 vcc, 1, v8
    s_cbranch_vccnz L_fs_95
L_fr_96:
    s_mov_b64 s[24:25], s[36:37]
    s_mov_b32 s26, 0x200000
    s_mov_b32 s27, 0x20000
    s_lshl_b32 s6, s38, 12
    ds_read_b32 v8, v6 offset:4
    s_waitcnt lgkmcnt(0)
    v_cmp_gt_u32 vcc, 8, v8
    s_cbranch_vccnz L_fs_98
L_fr_99:
    s_setprio 3
    s_nop 0
    buffer_load_dword v61, v61, s[24:27], s6 offen
    buffer_load_dwordx4 v[94:97], v2, s[52:55], s42 offen offset:0 sc1
    buffer_load_dword v102, v2, s[52:55], s42 offen offset:16 sc1
    buffer_load_dwordx4 v[98:101], v2, s[52:55], s42 offen offset:1024 sc1
    buffer_load_dword v103, v2, s[52:55], s42 offen offset:1040 sc1
    buffer_load_dwordx4 v[76:79], v50, s[8:11], s32 offen
    buffer_load_dwordx4 v[84:87], v89, s[44:47], s34 offen
    buffer_load_dwordx4 v[80:83], v88, s[52:55], s33 offen sc1
    s_setprio 0
    s_sub_u32 s3, 64, s40
    v_cmp_ne_u32 vcc, s3, v1
    s_waitcnt vmcnt(3)
    s_nop 0
    v_cndmask_b32 v103, 0, v103, vcc
    ds_write_b128 v65, v[94:97] offset:0
    v_alignbit_b32 v104, v95, v94, 16
    v_alignbit_b32 v105, v96, v95, 16
    v_alignbit_b32 v106, v97, v96, 16
    v_alignbit_b32 v107, v102, v97, 16
    ds_write_b128 v65, v[104:107] offset:4640
    ds_write_b128 v65, v[98:101] offset:1024
    v_alignbit_b32 v108, v99, v98, 16
    v_alignbit_b32 v109, v100, v99, 16
    v_alignbit_b32 v110, v101, v100, 16
    v_alignbit_b32 v111, v103, v101, 16
    ds_write_b128 v65, v[108:111] offset:5664
    s_waitcnt vmcnt(0)
    v_cmp_ne_u32 vcc, s56, v82
    s_cbranch_vccnz L_poll_101
L_pok_102:
    v_lshlrev_b32 v90, 16, v80
    v_and_b32 v92, s63, v80
    v_lshlrev_b32 v91, 16, v80
    v_rcp_f32 v92, v92
    v_lshlrev_b32 v26, 16, v76
    v_and_b32 v27, s63, v76
    v_lshlrev_b32 v28, 16, v77
    v_and_b32 v29, s63, v77
    v_lshlrev_b32 v30, 16, v78
    v_and_b32 v31, s63, v78
    v_lshlrev_b32 v32, 16, v79
    v_and_b32 v33, s63, v79
    v_mov_b32 v93, v92
    v_pk_add_f32 v[34:35], v[26:27], v[90:91] neg_lo:[0,1] neg_hi:[0,1]
    v_pk_add_f32 v[36:37], v[28:29], v[90:91] neg_lo:[0,1] neg_hi:[0,1]
    v_pk_add_f32 v[38:39], v[30:31], v[90:91] neg_lo:[0,1] neg_hi:[0,1]
    v_pk_add_f32 v[40:41], v[32:33], v[90:91] neg_lo:[0,1] neg_hi:[0,1]
    v_pk_mul_f32 v[34:35], v[34:35], v[92:93]
    v_pk_mul_f32 v[36:37], v[36:37], v[92:93]
    v_pk_mul_f32 v[38:39], v[38:39], v[92:93]
    v_pk_mul_f32 v[40:41], v[40:41], v[92:93]
    v_lshlrev_b32 v42, 16, v84
    v_and_b32 v43, s63, v84
    v_lshlrev_b32 v44, 16, v85
    v_and_b32 v45, s63, v85
    v_lshlrev_b32 v46, 16, v86
    v_and_b32 v47, s63, v86
    v_lshlrev_b32 v48, 16, v87
    v_and_b32 v49, s63, v87
    ds_read_b32 v8, v6 offset:12
    s_waitcnt lgkmcnt(0)
    v_cmp_gt_u32 vcc, 1, v8
    s_cbranch_vccnz L_fs_104
L_fr_105:
    ds_write_b32 v62, v61
    v_mov_b32 v12, 1
    ds_write_b32 v7, v12 offset:80
    ds_read_b32 v8, v70 offset:80
    s_waitcnt lgkmcnt(0)
    v_cmp_gt_u32 vcc, 1, v8
    s_cbranch_vccnz L_fs_107
L_fr_108:
    ds_read_b32 v8, v7 offset:176
    s_waitcnt lgkmcnt(0)
    v_cmp_gt_u32 vcc, 2, v8
    s_cbranch_vccnz L_fs_110
L_fr_111:
    ds_read_b64 v[58:59], v63 offset:0
    ds_read_b64 v[60:61], v63 offset:8
    ds_read_b128 v[74:77], v64 offset:3584
    ds_read_b128 v[78:81], v64 offset:3072
    ds_read_b128 v[82:85], v64 offset:2560
    ds_read_b128 v[86:89], v64 offset:2048
    ds_read_b128 v[90:93], v64 offset:1536
    ds_read_b128 v[94:97], v64 offset:1024
    ds_read_b128 v[98:101], v64 offset:512
    ds_read_b128 v[102:105], v64 offset:0
    s_waitcnt lgkmcnt(7)
    v_mfma_f32_16x16x32_bf16 v[136:139], v[58:61], v[74:77], 0
    ds_read_b64 v[106:107], v63 offset:512
    ds_read_b64 v[108:109], v63 offset:520
    s_waitcnt lgkmcnt(8)
    v_mfma_f32_16x16x32_bf16 v[140:143], v[58:61], v[78:81], 0
    ds_read_b64 v[110:111], v63 offset:1024
    ds_read_b64 v[112:113], v63 offset:1032
    s_waitcnt lgkmcnt(9)
    v_mfma_f32_16x16x32_bf16 v[144:147], v[58:61], v[82:85], 0
    ds_read_b64 v[114:115], v63 offset:1536
    ds_read_b64 v[116:117], v63 offset:1544
    s_waitcnt lgkmcnt(10)
    v_mfma_f32_16x16x32_bf16 v[148:151], v[58:61], v[86:89], 0
    ds_read_b64 v[118:119], v63 offset:2048
    ds_read_b64 v[120:121], v63 offset:2056
    s_waitcnt lgkmcnt(11)
    v_mfma_f32_16x16x32_bf16 v[152:155], v[58:61], v[90:93], 0
    ds_read_b64 v[122:123], v63 offset:2560
    ds_read_b64 v[124:125], v63 offset:2568
    s_waitcnt lgkmcnt(12)
    v_mfma_f32_16x16x32_bf16 v[156:159], v[58:61], v[94:97], 0
    s_waitcnt lgkmcnt(11)
    v_mfma_f32_16x16x32_bf16 v[160:163], v[58:61], v[98:101], 0
    ds_read_b64 v[126:127], v63 offset:3072
    ds_read_b64 v[128:129], v63 offset:3080
    s_waitcnt lgkmcnt(12)
    v_mfma_f32_16x16x32_bf16 v[164:167], v[58:61], v[102:105], 0
    s_waitcnt lgkmcnt(10)
    v_mfma_f32_16x16x32_bf16 v[140:143], v[106:109], v[74:77], v[140:143]
    ds_read_b64 v[130:131], v63 offset:3584
    ds_read_b64 v[132:133], v63 offset:3592
    v_mfma_f32_16x16x32_bf16 v[144:147], v[106:109], v[78:81], v[144:147]
    v_mfma_f32_16x16x32_bf16 v[148:151], v[106:109], v[82:85], v[148:151]
    v_mfma_f32_16x16x32_bf16 v[152:155], v[106:109], v[86:89], v[152:155]
    v_mfma_f32_16x16x32_bf16 v[156:159], v[106:109], v[90:93], v[156:159]
    v_mfma_f32_16x16x32_bf16 v[160:163], v[106:109], v[94:97], v[160:163]
    v_mfma_f32_16x16x32_bf16 v[164:167], v[106:109], v[98:101], v[164:167]
    s_waitcnt lgkmcnt(10)
    v_mfma_f32_16x16x32_bf16 v[144:147], v[110:113], v[74:77], v[144:147]
    ds_read_b64 v[58:59], v63 offset:64
    ds_read_b64 v[60:61], v63 offset:72
    v_mfma_f32_16x16x32_bf16 v[148:151], v[110:113], v[78:81], v[148:151]
    v_mfma_f32_16x16x32_bf16 v[152:155], v[110:113], v[82:85], v[152:155]
    v_mfma_f32_16x16x32_bf16 v[156:159], v[110:113], v[86:89], v[156:159]
    v_mfma_f32_16x16x32_bf16 v[160:163], v[110:113], v[90:93], v[160:163]
    v_mfma_f32_16x16x32_bf16 v[164:167], v[110:113], v[94:97], v[164:167]
    s_waitcnt lgkmcnt(10)
    v_mfma_f32_16x16x32_bf16 v[148:151], v[114:117], v[74:77], v[148:151]
    ds_read_b128 v[102:105], v64 offset:3648
    v_mfma_f32_16x16x32_bf16 v[152:155], v[114:117], v[78:81], v[152:155]
    ds_read_b128 v[106:109], v64 offset:3136
    v_mfma_f32_16x16x32_bf16 v[156:159], v[114:117], v[82:85], v[156:159]
    v_mfma_f32_16x16x32_bf16 v[160:163], v[114:117], v[86:89], v[160:163]
    v_mfma_f32_16x16x32_bf16 v[164:167], v[114:117], v[90:93], v[164:167]
    s_waitcnt lgkmcnt(10)
    v_mfma_f32_16x16x32_bf16 v[152:155], v[118:121], v[74:77], v[152:155]
    ds_read_b128 v[98:101], v64 offset:2624
    v_mfma_f32_16x16x32_bf16 v[156:159], v[118:121], v[78:81], v[156:159]
    ds_read_b128 v[110:113], v64 offset:2112
    v_mfma_f32_16x16x32_bf16 v[160:163], v[118:121], v[82:85], v[160:163]
    v_mfma_f32_16x16x32_bf16 v[164:167], v[118:121], v[86:89], v[164:167]
    s_waitcnt lgkmcnt(10)
    v_mfma_f32_16x16x32_bf16 v[156:159], v[122:125], v[74:77], v[156:159]
    ds_read_b128 v[94:97], v64 offset:1600
    v_mfma_f32_16x16x32_bf16 v[160:163], v[122:125], v[78:81], v[160:163]
    ds_read_b128 v[114:117], v64 offset:1088
    v_mfma_f32_16x16x32_bf16 v[164:167], v[122:125], v[82:85], v[164:167]
    s_waitcnt lgkmcnt(10)
    v_mfma_f32_16x16x32_bf16 v[160:163], v[126:129], v[74:77], v[160:163]
    ds_read_b128 v[90:93], v64 offset:576
    v_mfma_f32_16x16x32_bf16 v[164:167], v[126:129], v[78:81], v[164:167]
    ds_read_b128 v[118:121], v64 offset:64
    s_waitcnt lgkmcnt(10)
    v_mfma_f32_16x16x32_bf16 v[164:167], v[130:133], v[74:77], v[164:167]
    ds_read_b64 v[86:87], v63 offset:576
    ds_read_b64 v[88:89], v63 offset:584
    s_waitcnt lgkmcnt(9)
    v_mfma_f32_16x16x32_bf16 v[136:139], v[58:61], v[102:105], v[136:139]
    ds_read_b64 v[122:123], v63 offset:1088
    ds_read_b64 v[124:125], v63 offset:1096
    s_waitcnt lgkmcnt(10)
    v_mfma_f32_16x16x32_bf16 v[140:143], v[58:61], v[106:109], v[140:143]
    ds_read_b64 v[82:83], v63 offset:1600
    ds_read_b64 v[84:85], v63 offset:1608
    s_waitcnt lgkmcnt(11)
    v_mfma_f32_16x16x32_bf16 v[144:147], v[58:61], v[98:101], v[144:147]
    ds_read_b64 v[126:127], v63 offset:2112
    ds_read_b64 v[128:129], v63 offset:2120
    s_waitcnt lgkmcnt(12)
    v_mfma_f32_16x16x32_bf16 v[148:151], v[58:61], v[110:113], v[148:151]
    s_waitcnt lgkmcnt(11)
    v_mfma_f32_16x16x32_bf16 v[152:155], v[58:61], v[94:97], v[152:155]
    ds_read_b64 v[78:79], v63 offset:2624
    ds_read_b64 v[80:81], v63 offset:2632
    s_waitcnt lgkmcnt(12)
    v_mfma_f32_16x16x32_bf16 v[156:159], v[58:61], v[114:117], v[156:159]
    s_waitcnt lgkmcnt(11)
    v_mfma_f32_16x16x32_bf16 v[160:163], v[58:61], v[90:93], v[160:163]
    ds_read_b64 v[130:131], v63 offset:3136
    ds_read_b64 v[132:133], v63 offset:3144
    s_waitcnt lgkmcnt(12)
    v_mfma_f32_16x16x32_bf16 v[164:167], v[58:61], v[118:121], v[164:167]
    s_waitcnt lgkmcnt(10)
    v_mfma_f32_16x16x32_bf16 v[140:143], v[86:89], v[102:105], v[140:143]
    ds_read_b64 v[74:75], v63 offset:3648
    ds_read_b64 v[76:77], v63 offset:3656
    v_mfma_f32_16x16x32_bf16 v[144:147], v[86:89], v[106:109], v[144:147]
    v_mfma_f32_16x16x32_bf16 v[148:151], v[86:89], v[98:101], v[148:151]
    v_mfma_f32_16x16x32_bf16 v[152:155], v[86:89], v[110:113], v[152:155]
    v_mfma_f32_16x16x32_bf16 v[156:159], v[86:89], v[94:97], v[156:159]
    v_mfma_f32_16x16x32_bf16 v[160:163], v[86:89], v[114:117], v[160:163]
    v_mfma_f32_16x16x32_bf16 v[164:167], v[86:89], v[90:93], v[164:167]
    s_waitcnt lgkmcnt(10)
    v_mfma_f32_16x16x32_bf16 v[144:147], v[122:125], v[102:105], v[144:147]
    ds_read_b64 v[58:59], v63 offset:128
    ds_read_b64 v[60:61], v63 offset:136
    v_mfma_f32_16x16x32_bf16 v[148:151], v[122:125], v[106:109], v[148:151]
    v_mfma_f32_16x16x32_bf16 v[152:155], v[122:125], v[98:101], v[152:155]
    v_mfma_f32_16x16x32_bf16 v[156:159], v[122:125], v[110:113], v[156:159]
    v_mfma_f32_16x16x32_bf16 v[160:163], v[122:125], v[94:97], v[160:163]
    v_mfma_f32_16x16x32_bf16 v[164:167], v[122:125], v[114:117], v[164:167]
    s_waitcnt lgkmcnt(10)
    v_mfma_f32_16x16x32_bf16 v[148:151], v[82:85], v[102:105], v[148:151]
    ds_read_b128 v[118:121], v64 offset:3712
    v_mfma_f32_16x16x32_bf16 v[152:155], v[82:85], v[106:109], v[152:155]
    ds_read_b128 v[86:89], v64 offset:3200
    v_mfma_f32_16x16x32_bf16 v[156:159], v[82:85], v[98:101], v[156:159]
    v_mfma_f32_16x16x32_bf16 v[160:163], v[82:85], v[110:113], v[160:163]
    v_mfma_f32_16x16x32_bf16 v[164:167], v[82:85], v[94:97], v[164:167]
    s_waitcnt lgkmcnt(10)
    v_mfma_f32_16x16x32_bf16 v[152:155], v[126:129], v[102:105], v[152:155]
    ds_read_b128 v[90:93], v64 offset:2688
    v_mfma_f32_16x16x32_bf16 v[156:159], v[126:129], v[106:109], v[156:159]
    ds_read_b128 v[122:125], v64 offset:2176
    v_mfma_f32_16x16x32_bf16 v[160:163], v[126:129], v[98:101], v[160:163]
    v_mfma_f32_16x16x32_bf16 v[164:167], v[126:129], v[110:113], v[164:167]
    s_waitcnt lgkmcnt(10)
    v_mfma_f32_16x16x32_bf16 v[156:159], v[78:81], v[102:105], v[156:159]
    ds_read_b128 v[114:117], v64 offset:1664
    v_mfma_f32_16x16x32_bf16 v[160:163], v[78:81], v[106:109], v[160:163]
    ds_read_b128 v[82:85], v64 offset:1152
    v_mfma_f32_16x16x32_bf16 v[164:167], v[78:81], v[98:101], v[164:167]
    s_waitcnt lgkmcnt(10)
    v_mfma_f32_16x16x32_bf16 v[160:163], v[130:133], v[102:105], v[160:163]
    ds_read_b128 v[94:97], v64 offset:640
    v_mfma_f32_16x16x32_bf16 v[164:167], v[130:133], v[106:109], v[164:167]
    ds_read_b128 v[126:129], v64 offset:128
    s_waitcnt lgkmcnt(10)
    v_mfma_f32_16x16x32_bf16 v[164:167], v[74:77], v[102:105], v[164:167]
    ds_read_b64 v[110:111], v63 offset:640
    ds_read_b64 v[112:113], v63 offset:648
    s_waitcnt lgkmcnt(9)
    v_mfma_f32_16x16x32_bf16 v[136:139], v[58:61], v[118:121], v[136:139]
    ds_read_b64 v[78:79], v63 offset:1152
    ds_read_b64 v[80:81], v63 offset:1160
    s_waitcnt lgkmcnt(10)
    v_mfma_f32_16x16x32_bf16 v[140:143], v[58:61], v[86:89], v[140:143]
    ds_read_b64 v[98:99], v63 offset:1664
    ds_read_b64 v[100:101], v63 offset:1672
    s_waitcnt lgkmcnt(11)
    v_mfma_f32_16x16x32_bf16 v[144:147], v[58:61], v[90:93], v[144:147]
    ds_read_b64 v[130:131], v63 offset:2176
    ds_read_b64 v[132:133], v63 offset:2184
    s_waitcnt lgkmcnt(12)
    v_mfma_f32_16x16x32_bf16 v[148:151], v[58:61], v[122:125], v[148:151]
    s_waitcnt lgkmcnt(11)
    v_mfma_f32_16x16x32_bf16 v[152:155], v[58:61], v[114:117], v[152:155]
    ds_read_b64 v[106:107], v63 offset:2688
    ds_read_b64 v[108:109], v63 offset:2696
    s_waitcnt lgkmcnt(12)
    v_mfma_f32_16x16x32_bf16 v[156:159], v[58:61], v[82:85], v[156:159]
    s_waitcnt lgkmcnt(11)
    v_mfma_f32_16x16x32_bf16 v[160:163], v[58:61], v[94:97], v[160:163]
    ds_read_b64 v[74:75], v63 offset:3200
    ds_read_b64 v[76:77], v63 offset:3208
    s_waitcnt lgkmcnt(12)
    v_mfma_f32_16x16x32_bf16 v[164:167], v[58:61], v[126:129], v[164:167]
    s_waitcnt lgkmcnt(10)
    v_mfma_f32_16x16x32_bf16 v[140:143], v[110:113], v[118:121], v[140:143]
    ds_read_b64 v[102:103], v63 offset:3712
    ds_read_b64 v[104:105], v63 offset:3720
    v_mfma_f32_16x16x32_bf16 v[144:147], v[110:113], v[86:89], v[144:147]
    v_mfma_f32_16x16x32_bf16 v[148:151], v[110:113], v[90:93], v[148:151]
    v_mfma_f32_16x16x32_bf16 v[152:155], v[110:113], v[122:125], v[152:155]
    v_mfma_f32_16x16x32_bf16 v[156:159], v[110:113], v[114:117], v[156:159]
    v_mfma_f32_16x16x32_bf16 v[160:163], v[110:113], v[82:85], v[160:163]
    v_mfma_f32_16x16x32_bf16 v[164:167], v[110:113], v[94:97], v[164:167]
    s_waitcnt lgkmcnt(10)
    v_mfma_f32_16x16x32_bf16 v[144:147], v[78:81], v[118:121], v[144:147]
    ds_read_b64 v[58:59], v63 offset:192
    ds_read_b64 v[60:61], v63 offset:200
    v_mfma_f32_16x16x32_bf16 v[148:151], v[78:81], v[86:89], v[148:151]
    v_mfma_f32_16x16x32_bf16 v[152:155], v[78:81], v[90:93], v[152:155]
    v_mfma_f32_16x16x32_bf16 v[156:159], v[78:81], v[122:125], v[156:159]
    v_mfma_f32_16x16x32_bf16 v[160:163], v[78:81], v[114:117], v[160:163]
    v_mfma_f32_16x16x32_bf16 v[164:167], v[78:81], v[82:85], v[164:167]
    s_waitcnt lgkmcnt(10)
    v_mfma_f32_16x16x32_bf16 v[148:151], v[98:101], v[118:121], v[148:151]
    ds_read_b128 v[126:129], v64 offset:3776
    v_mfma_f32_16x16x32_bf16 v[152:155], v[98:101], v[86:89], v[152:155]
    ds_read_b128 v[110:113], v64 offset:3264
    v_mfma_f32_16x16x32_bf16 v[156:159], v[98:101], v[90:93], v[156:159]
    v_mfma_f32_16x16x32_bf16 v[160:163], v[98:101], v[122:125], v[160:163]
    v_mfma_f32_16x16x32_bf16 v[164:167], v[98:101], v[114:117], v[164:167]
    s_waitcnt lgkmcnt(10)
    v_mfma_f32_16x16x32_bf16 v[152:155], v[130:133], v[118:121], v[152:155]
    ds_read_b128 v[94:97], v64 offset:2752
    v_mfma_f32_16x16x32_bf16 v[156:159], v[130:133], v[86:89], v[156:159]
    ds_read_b128 v[78:81], v64 offset:2240
    v_mfma_f32_16x16x32_bf16 v[160:163], v[130:133], v[90:93], v[160:163]
    v_mfma_f32_16x16x32_bf16 v[164:167], v[130:133], v[122:125], v[164:167]
    s_waitcnt lgkmcnt(10)
    v_mfma_f32_16x16x32_bf16 v[156:159], v[106:109], v[118:121], v[156:159]
    ds_read_b128 v[82:85], v64 offset:1728
    v_mfma_f32_16x16x32_bf16 v[160:163], v[106:109], v[86:89], v[160:163]
    ds_read_b128 v[98:101], v64 offset:1216
    v_mfma_f32_16x16x32_bf16 v[164:167], v[106:109], v[90:93], v[164:167]
    s_waitcnt lgkmcnt(10)
    v_mfma_f32_16x16x32_bf16 v[160:163], v[74:77], v[118:121], v[160:163]
    ds_read_b128 v[114:117], v64 offset:704
    v_mfma_f32_16x16x32_bf16 v[164:167], v[74:77], v[86:89], v[164:167]
    ds_read_b128 v[130:133], v64 offset:192
    s_waitcnt lgkmcnt(10)
    v_mfma_f32_16x16x32_bf16 v[164:167], v[102:105], v[118:121], v[164:167]
    ds_read_b64 v[122:123], v63 offset:704
    ds_read_b64 v[124:125], v63 offset:712
    s_waitcnt lgkmcnt(9)
    v_mfma_f32_16x16x32_bf16 v[136:139], v[58:61], v[126:129], v[136:139]
    ds_read_b64 v[106:107], v63 offset:1216
    ds_read_b64 v[108:109], v63 offset:1224
    s_waitcnt lgkmcnt(10)
    v_mfma_f32_16x16x32_bf16 v[140:143], v[58:61], v[110:113], v[140:143]
    ds_read_b64 v[90:91], v63 offset:1728
    ds_read_b64 v[92:93], v63 offset:1736
    s_waitcnt lgkmcnt(11)
    v_mfma_f32_16x16x32_bf16 v[144:147], v[58:61], v[94:97], v[144:147]
    ds_read_b64 v[74:75], v63 offset:2240
    ds_read_b64 v[76:77], v63 offset:2248
    s_waitcnt lgkmcnt(12)
    v_mfma_f32_16x16x32_bf16 v[148:151], v[58:61], v[78:81], v[148:151]
    s_waitcnt lgkmcnt(11)
    v_mfma_f32_16x16x32_bf16 v[152:155], v[58:61], v[82:85], v[152:155]
    ds_read_b64 v[86:87], v63 offset:2752
    ds_read_b64 v[88:89], v63 offset:2760
    s_waitcnt lgkmcnt(12)
    v_mfma_f32_16x16x32_bf16 v[156:159], v[58:61], v[98:101], v[156:159]
    s_waitcnt lgkmcnt(11)
    v_mfma_f32_16x16x32_bf16 v[160:163], v[58:61], v[114:117], v[160:163]
    ds_read_b64 v[102:103], v63 offset:3264
    ds_read_b64 v[104:105], v63 offset:3272
    s_waitcnt lgkmcnt(12)
    v_mfma_f32_16x16x32_bf16 v[164:167], v[58:61], v[130:133], v[164:167]
    s_waitcnt lgkmcnt(10)
    v_mfma_f32_16x16x32_bf16 v[140:143], v[122:125], v[126:129], v[140:143]
    ds_read_b64 v[118:119], v63 offset:3776
    ds_read_b64 v[120:121], v63 offset:3784
    v_mfma_f32_16x16x32_bf16 v[144:147], v[122:125], v[110:113], v[144:147]
    v_mfma_f32_16x16x32_bf16 v[148:151], v[122:125], v[94:97], v[148:151]
    v_mfma_f32_16x16x32_bf16 v[152:155], v[122:125], v[78:81], v[152:155]
    v_mfma_f32_16x16x32_bf16 v[156:159], v[122:125], v[82:85], v[156:159]
    v_mfma_f32_16x16x32_bf16 v[160:163], v[122:125], v[98:101], v[160:163]
    v_mfma_f32_16x16x32_bf16 v[164:167], v[122:125], v[114:117], v[164:167]
    s_waitcnt lgkmcnt(10)
    v_mfma_f32_16x16x32_bf16 v[144:147], v[106:109], v[126:129], v[144:147]
    ds_read_b128 v[58:61], v66 offset:1536
    v_mfma_f32_16x16x32_bf16 v[148:151], v[106:109], v[110:113], v[148:151]
    ds_read_b128 v[130:133], v66 offset:1024
    v_mfma_f32_16x16x32_bf16 v[152:155], v[106:109], v[94:97], v[152:155]
    v_mfma_f32_16x16x32_bf16 v[156:159], v[106:109], v[78:81], v[156:159]
    v_mfma_f32_16x16x32_bf16 v[160:163], v[106:109], v[82:85], v[160:163]
    v_mfma_f32_16x16x32_bf16 v[164:167], v[106:109], v[98:101], v[164:167]
    s_waitcnt lgkmcnt(10)
    v_mfma_f32_16x16x32_bf16 v[148:151], v[90:93], v[126:129], v[148:151]
    ds_read_b128 v[122:125], v66 offset:512
    v_mfma_f32_16x16x32_bf16 v[152:155], v[90:93], v[110:113], v[152:155]
    ds_read_b128 v[114:117], v66 offset:0
    v_mfma_f32_16x16x32_bf16 v[156:159], v[90:93], v[94:97], v[156:159]
    v_mfma_f32_16x16x32_bf16 v[160:163], v[90:93], v[78:81], v[160:163]
    v_mfma_f32_16x16x32_bf16 v[164:167], v[90:93], v[82:85], v[164:167]
    s_waitcnt lgkmcnt(10)
    v_mfma_f32_16x16x32_bf16 v[152:155], v[74:77], v[126:129], v[152:155]
    v_mov_b32 v12, 2
    ds_write_b32 v7, v12 offset:80
    v_mfma_f32_16x16x32_bf16 v[156:159], v[74:77], v[110:113], v[156:159]
    v_mfma_f32_16x16x32_bf16 v[160:163], v[74:77], v[94:97], v[160:163]
    v_mfma_f32_16x16x32_bf16 v[164:167], v[74:77], v[78:81], v[164:167]
    s_waitcnt lgkmcnt(9)
    v_mfma_f32_16x16x32_bf16 v[156:159], v[86:89], v[126:129], v[156:159]
    v_mfma_f32_16x16x32_bf16 v[160:163], v[86:89], v[110:113], v[160:163]
    v_mfma_f32_16x16x32_bf16 v[164:167], v[86:89], v[94:97], v[164:167]
    s_waitcnt lgkmcnt(7)
    v_mfma_f32_16x16x32_bf16 v[160:163], v[102:105], v[126:129], v[160:163]
    v_mfma_f32_16x16x32_bf16 v[164:167], v[102:105], v[110:113], v[164:167]
    s_waitcnt lgkmcnt(5)
    v_mfma_f32_16x16x32_bf16 v[164:167], v[118:121], v[126:129], v[164:167]
    ds_read_b32 v8, v70 offset:80
    s_waitcnt lgkmcnt(0)
    v_cmp_gt_u32 vcc, 2, v8
    s_cbranch_vccnz L_fs_113
L_fr_114:
    s_cmp_eq_u32 s40, 0
    s_cbranch_scc0 L_cx1
    ds_write_b128 v71, v[152:155] offset:0
    ds_write_b128 v71, v[156:159] offset:1024
    ds_write_b128 v71, v[160:163] offset:2048
    ds_write_b128 v71, v[164:167] offset:3072
    s_branch L_cxE
L_cx1:
    s_nop 0
    ds_write_b128 v71, v[136:139] offset:0
    ds_write_b128 v71, v[140:143] offset:1024
    ds_write_b128 v71, v[144:147] offset:2048
    ds_write_b128 v71, v[148:151] offset:3072
    v_mov_b64 v[136:137], v[152:153]
    v_mov_b64 v[138:139], v[154:155]
    v_mov_b64 v[140:141], v[156:157]
    v_mov_b64 v[142:143], v[158:159]
    v_mov_b64 v[144:145], v[160:161]
    v_mov_b64 v[146:147], v[162:163]
    v_mov_b64 v[148:149], v[164:165]
    v_mov_b64 v[150:151], v[166:167]
L_cxE:
    v_mov_b32_e64 v12, 3
    ds_write_b32 v7, v12 offset:80
    v_lshlrev_b32 v106, 16, v61
    v_lshlrev_b32 v107, 16, v60
    v_lshlrev_b32 v108, 16, v59
    v_lshlrev_b32 v109, 16, v58
    v_lshlrev_b32 v98, 16, v133
    v_lshlrev_b32 v99, 16, v132
    v_lshlrev_b32 v100, 16, v131
    v_lshlrev_b32 v101, 16, v130
    v_lshlrev_b32 v90, 16, v125
    v_lshlrev_b32 v91, 16, v124
    v_lshlrev_b32 v92, 16, v123
    v_lshlrev_b32 v93, 16, v122
    v_lshlrev_b32 v82, 16, v117
    v_lshlrev_b32 v83, 16, v116
    v_lshlrev_b32 v84, 16, v115
    v_lshlrev_b32_e64 v85, 16, v114
    s_waitcnt lgkmcnt(0)
    ds_read_b32 v8, v70 offset:80
    s_waitcnt lgkmcnt(0)
    v_cmp_gt_u32 vcc, 3, v8
    s_cbranch_vccnz L_fs_116
L_fr_117:
    s_nop 0
    ds_read_b128 v[74:77], v72 offset:0
    ds_read_b128 v[78:81], v72 offset:1024
    ds_read_b128 v[86:89], v72 offset:2048
    ds_read_b128 v[94:97], v72 offset:3072
    v_mov_b32_e64 v12, 1
    ds_write_b32 v7, v12 offset:160
    s_waitcnt lgkmcnt(4)
    s_nop 0
    v_pk_add_f32 v[136:137], v[136:137], v[74:75]
    v_pk_add_f32 v[138:139], v[138:139], v[76:77]
    v_pk_fma_f32 v[106:107], v[106:107], s[70:71], v[136:137]
    v_pk_fma_f32 v[108:109], v[108:109], s[70:71], v[138:139]
    v_cvt_pk_bf16_f32 v102, v106, v107
    v_cvt_pk_bf16_f32 v103, v108, v109
    s_waitcnt lgkmcnt(3)
    s_nop 0
    v_pk_add_f32 v[140:141], v[140:141], v[78:79]
    v_pk_add_f32 v[142:143], v[142:143], v[80:81]
    v_pk_fma_f32 v[98:99], v[98:99], s[70:71], v[140:141]
    v_pk_fma_f32 v[100:101], v[100:101], s[70:71], v[142:143]
    v_cvt_pk_bf16_f32 v104, v98, v99
    v_cvt_pk_bf16_f32 v105, v100, v101
    s_waitcnt lgkmcnt(2)
    s_nop 0
    v_pk_add_f32 v[144:145], v[144:145], v[86:87]
    v_pk_add_f32 v[146:147], v[146:147], v[88:89]
    v_pk_fma_f32 v[90:91], v[90:91], s[70:71], v[144:145]
    v_pk_fma_f32 v[92:93], v[92:93], s[70:71], v[146:147]
    v_cvt_pk_bf16_f32 v110, v90, v91
    v_cvt_pk_bf16_f32 v111, v92, v93
    s_waitcnt lgkmcnt(1)
    s_nop 0
    v_pk_add_f32 v[148:149], v[148:149], v[94:95]
    v_pk_add_f32 v[150:151], v[150:151], v[96:97]
    v_pk_fma_f32 v[82:83], v[82:83], s[70:71], v[148:149]
    v_pk_fma_f32 v[84:85], v[84:85], s[70:71], v[150:151]
    v_cvt_pk_bf16_f32 v112, v82, v83
    v_cvt_pk_bf16_f32 v113, v84, v85
    s_mov_b32 vcc_lo, 0xaaaaaaaa
    s_mov_b32 vcc_hi, 0xaaaaaaaa
    v_cndmask_b32 v118, v104, v102, vcc
    v_cndmask_b32 v120, v102, v104, vcc
    v_cndmask_b32 v119, v105, v103, vcc
    v_cndmask_b32 v121, v103, v105, vcc
    v_mov_b32_dpp v102, v118 quad_perm:[1,0,3,2] row_mask:0xf bank_mask:0xf
    v_mov_b32_dpp v103, v119 quad_perm:[1,0,3,2] row_mask:0xf bank_mask:0xf
    v_perm_b32 v58, v102, v120, v68
    v_perm_b32 v59, v102, v120, v69
    v_perm_b32 v60, v103, v121, v68
    v_perm_b32 v61, v103, v121, v69
    buffer_store_dwordx4 v[58:61], v67, s[52:55], s43 offen offset:0 sc1
    v_cndmask_b32 v126, v112, v110, vcc
    v_cndmask_b32 v128, v110, v112, vcc
    v_cndmask_b32 v127, v113, v111, vcc
    v_cndmask_b32 v129, v111, v113, vcc
    v_mov_b32_dpp v110, v126 quad_perm:[1,0,3,2] row_mask:0xf bank_mask:0xf
    v_mov_b32_dpp v111, v127 quad_perm:[1,0,3,2] row_mask:0xf bank_mask:0xf
    v_perm_b32 v130, v110, v128, v68
    v_perm_b32 v131, v110, v128, v69
    v_perm_b32 v132, v111, v129, v68
    v_perm_b32 v133, v111, v129, v69
    buffer_store_dwordx4 v[130:133], v67, s[52:55], s43 offen offset:1024 sc1
    ds_read_b32 v8, v57 offset:120
    s_waitcnt lgkmcnt(0)
    v_cmp_gt_u32 vcc, 1, v8
    s_cbranch_vccnz L_fs_119
L_fr_120:
    s_cmp_lt_u32 0, s67
    s_cselect_b32 s3, s28, s29
    s_add_u32 s3, s3, 0
    buffer_load_dwordx4 v[136:139], v2, s[52:55], s3 offen sc1
    s_cmp_lt_u32 1, s67
    s_cselect_b32 s3, s28, s29
    s_add_u32 s3, s3, 1024
    buffer_load_dwordx4 v[140:143], v2, s[52:55], s3 offen sc1
    s_cmp_lt_u32 2, s67
    s_cselect_b32 s3, s28, s29
    s_add_u32 s3, s3, 2048
    buffer_load_dwordx4 v[144:147], v2, s[52:55], s3 offen sc1
    s_cmp_lt_u32 3, s67
    s_cselect_b32 s3, s28, s29
    s_add_u32 s3, s3, 3072
    buffer_load_dwordx4 v[148:151], v2, s[52:55], s3 offen sc1
    s_waitcnt vmcnt(4)
    buffer_store_dword v5, v13, s[52:55], s100 offen sc1
    s_branch L_G
L_fs_88:
L_fl_90:
    s_sleep 1
    ds_read_b32 v8, v6 offset:0
    s_waitcnt lgkmcnt(0)
    v_cmp_gt_u32 vcc, 5, v8
    s_cbranch_vccnz L_fl_90
    s_branch L_fr_89
L_fs_95:
L_fl_97:
    s_sleep 1
    ds_read_b32 v8, v6 offset:192
    s_waitcnt lgkmcnt(0)
    v_cmp_gt_u32 vcc, 1, v8
    s_cbranch_vccnz L_fl_97
    s_branch L_fr_96
L_fs_98:
L_fl_100:
    s_sleep 1
    ds_read_b32 v8, v6 offset:4
    s_waitcnt lgkmcnt(0)
    v_cmp_gt_u32 vcc, 8, v8
    s_cbranch_vccnz L_fl_100
    s_branch L_fr_99
L_poll_101:
    s_mov_b32 s7, 32768
L_pl_103:
    s_sleep 2
    buffer_load_dwordx4 v[80:83], v88, s[52:55], s33 offen sc1
    s_waitcnt vmcnt(0)
    v_cmp_ne_u32 vcc, s56, v82
    s_cbranch_vccz L_pok_102
    s_sub_u32 s7, s7, 1
    s_cbranch_scc0 L_pl_103
    s_branch L_pok_102
L_fs_104:
L_fl_106:
    s_sleep 1
    ds_read_b32 v8, v6 offset:12
    s_waitcnt lgkmcnt(0)
    v_cmp_gt_u32 vcc, 1, v8
    s_cbranch_vccnz L_fl_106
    s_branch L_fr_105
L_fs_107:
L_fl_109:
    s_sleep 1
    ds_read_b32 v8, v70 offset:80
    s_waitcnt lgkmcnt(0)
    v_cmp_gt_u32 vcc, 1, v8
    s_cbranch_vccnz L_fl_109
    s_branch L_fr_108
L_fs_110:
L_fl_112:
    s_sleep 1
    ds_read_b32 v8, v7 offset:176
    s_waitcnt lgkmcnt(0)
    v_cmp_gt_u32 vcc, 2, v8
    s_cbranch_vccnz L_fl_112
    s_branch L_fr_111
L_fs_113:
L_fl_115:
    s_sleep 1
    ds_read_b32 v8, v70 offset:80
    s_waitcnt lgkmcnt(0)
    v_cmp_gt_u32 vcc, 2, v8
    s_cbranch_vccnz L_fl_115
    s_branch L_fr_114
L_fs_116:
L_fl_118:
    s_sleep 1
    ds_read_b32 v8, v70 offset:80
    s_waitcnt lgkmcnt(0)
    v_cmp_gt_u32 vcc, 3, v8
    s_cbranch_vccnz L_fl_118
    s_branch L_fr_117
L_fs_119:
L_fl_121:
    s_sleep 1
    ds_read_b32 v8, v57 offset:120
    s_waitcnt lgkmcnt(0)
    v_cmp_gt_u32 vcc, 1, v8
    s_cbranch_vccnz L_fl_121
    s_branch L_fr_120
L_mainA:
    s_cmp_lg_u32 s69, 0
    s_cbranch_scc1 L_freeA
    v_and_b32_e64 v44, 31, v1
    v_bfe_u32 v45, v1, 1, 3
    v_lshrrev_b32 v46, 5, v1
    v_xor_b32 v45, v45, v46
    v_lshlrev_b32 v39, 4, v44
    v_lshlrev_b32 v44, 7, v44
    s_lshl_b32 s3, s65, 12
    v_add_u32 v44, s3, v44
    v_xor_b32_e64 v14, 0, v45
    v_lshl_add_u32 v14, v14, 4, v44
    v_xor_b32_e64 v15, 2, v45
    v_lshl_add_u32 v15, v15, 4, v44
    v_xor_b32_e64 v16, 4, v45
    v_lshl_add_u32 v16, v16, 4, v44
    v_xor_b32_e64 v17, 6, v45
    v_lshl_add_u32 v17, v17, 4, v44
    v_bfe_u32 v45, v1, 2, 2
    v_lshl_add_u32 v44, v46, 3, v45
    v_lshlrev_b32_e64 v44, 8, v44
    v_bfe_u32 v3, v1, 4, 1
    v_lshl_add_u32 v44, v3, 5, v44
    v_mul_u32_u24 v38, 44032, v3
    v_and_b32_e64 v3, 3, v1
    v_lshl_add_u32 v44, v3, 3, v44
    v_add_u32 v44, 65536, v44
    v_lshl_add_u32 v38, v46, 8, v38
    v_and_b32_e64 v3, 15, v1
    v_lshl_add_u32 v38, v3, 4, v38
    v_lshlrev_b32_e64 v46, 4, v46
    v_add_u32 v46, 160512, v46
    s_lshl_b32 s3, s60, 2
    s_add_u32 s3, s3, s65
    s_lshl_b32 s16, s3, 9
    s_add_u32 s16, s16, 65536
    s_mul_i32 s6, s3, 86
    s_add_u32 s6, s6, s61
    s_lshl_b32 s3, s3, 8
    s_add_u32 s3, s3, s64
    s_lshl_b32 s3, s3, 2
    s_add_u32 s100, s3, 196608
    s_add_u32 s3, s65, 0
    s_and_b32 s3, s3, 3
    v_xor_b32 v18, s3, v45
    v_lshl_add_u32 v18, v18, 6, v44
    s_lshl_b32 s4, s3, 7
    v_add_u32 v22, s4, v46
    s_add_u32 s5, s3, s6
    s_lshl_b32 s5, s5, 10
    s_add_u32 s5, s5, 5242880
    s_add_u32 s3, s3, s61
    s_cmp_lt_u32 s3, 43
    s_cselect_b32 s12, s5, 0x7ff00000
    s_add_u32 s3, s65, 1
    s_and_b32 s3, s3, 3
    v_xor_b32_e64 v19, s3, v45
    v_lshl_add_u32 v19, v19, 6, v44
    s_lshl_b32 s4, s3, 7
    v_add_u32 v23, s4, v46
    s_add_u32 s5, s3, s6
    s_lshl_b32 s5, s5, 10
    s_add_u32 s5, s5, 5242880
    s_add_u32 s3, s3, s61
    s_cmp_lt_u32 s3, 43
    s_cselect_b32 s13, s5, 0x7ff00000
    s_add_u32 s3, s65, 2
    s_and_b32 s3, s3, 3
    v_xor_b32_e64 v20, s3, v45
    v_lshl_add_u32 v20, v20, 6, v44
    s_lshl_b32 s4, s3, 7
    v_add_u32 v24, s4, v46
    s_add_u32 s5, s3, s6
    s_lshl_b32 s5, s5, 10
    s_add_u32 s5, s5, 5242880
    s_add_u32 s3, s3, s61
    s_cmp_lt_u32 s3, 43
    s_cselect_b32 s14, s5, 0x7ff00000
    s_add_u32 s3, s65, 3
    s_and_b32 s3, s3, 3
    v_xor_b32_e64 v21, s3, v45
    v_lshl_add_u32 v21, v21, 6, v44
    s_lshl_b32 s4, s3, 7
    v_add_u32 v25, s4, v46
    s_add_u32 s5, s3, s6
    s_lshl_b32 s5, s5, 10
    s_add_u32 s5, s5, 5242880
    s_add_u32 s3, s3, s61
    s_cmp_lt_u32 s3, 43
    s_cselect_b32 s15, s5, 0x7ff00000
    v_lshrrev_b32 v44, 4, v1
    v_xor_b32 v45, v44, v1
    v_and_b32 v45, 1, v45
    v_cmp_eq_u32 vcc, 0, v45
    v_and_b32 v45, 1, v1
    v_lshlrev_b32 v45, 6, v45
    v_lshl_add_u32 v45, v44, 4, v45
    s_lshl_b32 s3, s65, 7
    s_add_u32 s3, s3, 160512
    v_add_u32 v41, s3, v45
    v_mov_b32 v44, 0x3f803f80
    s_setprio 1
    v_cndmask_b32 v26, 0, v44, vcc
    v_cndmask_b32 v27, 0, v44, vcc
    v_cndmask_b32 v28, 0, v44, vcc
    v_cndmask_b32 v29, 0, v44, vcc
    ds_read_b32 v8, v6 offset:0
    s_waitcnt lgkmcnt(0)
    v_cmp_gt_u32 vcc, 1, v8
    s_cbranch_vccnz L_fs_122
L_fr_123:
    ds_read_b64_tr_b16 v[48:49], v18 offset:0
    ds_read_b64_tr_b16 v[50:51], v18 offset:1024
    ds_read_b128 v[44:47], v14 offset:0
    ds_read_b64_tr_b16 v[52:53], v19 offset:0
    ds_read_b64_tr_b16 v[54:55], v19 offset:1024
    ds_read_b64_tr_b16 v[56:57], v20 offset:0
    ds_read_b64_tr_b16 v[58:59], v20 offset:1024
    ds_read_b64_tr_b16 v[60:61], v21 offset:0
    ds_read_b64_tr_b16 v[62:63], v21 offset:1024
    v_mov_b32 v42, 0xc0135761
    v_mov_b32 v43, 0xc0135761
    s_mov_b32 s18, 0xbdd2d3e8
    s_mov_b32 s19, 0xbdd2d3e8
    s_lshl_b32 s3, s65, 9
    s_add_u32 s3, s3, 161664
    v_add_u32 v40, s3, v39
    ds_read_b64_tr_b16 v[68:69], v18 offset:4096
    ds_read_b64_tr_b16 v[70:71], v18 offset:5120
    ds_read_b128 v[64:67], v15 offset:0
    ds_read_b64_tr_b16 v[72:73], v19 offset:4096
    ds_read_b64_tr_b16 v[74:75], v19 offset:5120
    s_waitcnt lgkmcnt(9)
    v_mfma_f32_16x16x32_bf16 v[30:33], v[48:51], v[26:29], 0
    v_mfma_f32_32x32x16_bf16 v[104:119], v[48:51], v[44:47], 0
    ds_read_b64_tr_b16 v[76:77], v20 offset:4096
    ds_read_b64_tr_b16 v[78:79], v20 offset:5120
    ds_read_b64_tr_b16 v[80:81], v21 offset:4096
    v_mfma_f32_32x32x16_bf16 v[120:135], v[52:55], v[44:47], 0
    ds_read_b64_tr_b16 v[82:83], v21 offset:5120
    ds_read_b64_tr_b16 v[88:89], v18 offset:8192
    s_waitcnt lgkmcnt(10)
    v_mfma_f32_32x32x16_bf16 v[136:151], v[56:59], v[44:47], 0
    ds_read_b64_tr_b16 v[90:91], v18 offset:9216
    ds_read_b128 v[84:87], v16 offset:0
    ds_read_b64_tr_b16 v[92:93], v19 offset:8192
    v_mfma_f32_32x32x16_bf16 v[152:167], v[60:63], v[44:47], 0
    ds_read_b64_tr_b16 v[94:95], v19 offset:9216
    s_waitcnt lgkmcnt(9)
    v_mfma_f32_16x16x32_bf16 v[30:33], v[68:71], v[26:29], v[30:33]
    v_mfma_f32_32x32x16_bf16 v[104:119], v[68:71], v[64:67], v[104:119]
    s_nop 0
    ds_read_b32 v8, v6 offset:4
    ds_read_b64_tr_b16 v[96:97], v20 offset:8192
    ds_read_b64_tr_b16 v[98:99], v20 offset:9216
    ds_read_b64_tr_b16 v[100:101], v21 offset:8192
    v_mfma_f32_32x32x16_bf16 v[120:135], v[72:75], v[64:67], v[120:135]
    ds_read_b64_tr_b16 v[102:103], v21 offset:9216
    s_waitcnt lgkmcnt(10)
    v_mfma_f32_32x32x16_bf16 v[136:151], v[76:79], v[64:67], v[136:151]
    ds_read_b64_tr_b16 v[48:49], v18 offset:12288
    ds_read_b64_tr_b16 v[50:51], v18 offset:13312
    ds_read_b128 v[44:47], v17 offset:0
    v_mfma_f32_32x32x16_bf16 v[152:167], v[80:83], v[64:67], v[152:167]
    s_waitcnt lgkmcnt(7)
    v_cmp_gt_u32 vcc, 2, v8
    s_cbranch_vccnz L_fs_125
L_fr_126:
    ds_read_b64_tr_b16 v[52:53], v19 offset:12288
    ds_read_b64_tr_b16 v[54:55], v19 offset:13312
    ds_read_b64_tr_b16 v[56:57], v20 offset:12288
    v_mfma_f32_16x16x32_bf16 v[30:33], v[88:91], v[26:29], v[30:33]
    v_mfma_f32_32x32x16_bf16 v[104:119], v[88:91], v[84:87], v[104:119]
    ds_read_b64_tr_b16 v[58:59], v20 offset:13312
    ds_read_b64_tr_b16 v[60:61], v21 offset:12288
    ds_read_b64_tr_b16 v[62:63], v21 offset:13312
    v_mfma_f32_32x32x16_bf16 v[120:135], v[92:95], v[84:87], v[120:135]
    v_mov_b32_e64 v12, 1
    ds_write_b32 v7, v12 offset:16
    s_waitcnt lgkmcnt(10)
    v_mfma_f32_32x32x16_bf16 v[136:151], v[96:99], v[84:87], v[136:151]
    ds_read_b64_tr_b16 v[68:69], v18 offset:16384
    ds_read_b64_tr_b16 v[70:71], v18 offset:17408
    ds_read_b128 v[64:67], v14 offset:16384
    v_mfma_f32_32x32x16_bf16 v[152:167], v[100:103], v[84:87], v[152:167]
    ds_read_b64_tr_b16 v[72:73], v19 offset:16384
    s_waitcnt lgkmcnt(9)
    v_mfma_f32_16x16x32_bf16 v[30:33], v[48:51], v[26:29], v[30:33]
    v_mfma_f32_32x32x16_bf16 v[104:119], v[48:51], v[44:47], v[104:119]
    ds_read_b64_tr_b16 v[74:75], v19 offset:17408
    ds_read_b64_tr_b16 v[76:77], v20 offset:16384
    ds_read_b64_tr_b16 v[78:79], v20 offset:17408
    v_mfma_f32_32x32x16_bf16 v[120:135], v[52:55], v[44:47], v[120:135]
    ds_read_b64_tr_b16 v[80:81], v21 offset:16384
    ds_read_b64_tr_b16 v[82:83], v21 offset:17408
    s_waitcnt lgkmcnt(10)
    v_mfma_f32_32x32x16_bf16 v[136:151], v[56:59], v[44:47], v[136:151]
    ds_read_b64_tr_b16 v[88:89], v18 offset:20480
    ds_read_b64_tr_b16 v[90:91], v18 offset:21504
    ds_read_b128 v[84:87], v15 offset:16384
    v_mfma_f32_32x32x16_bf16 v[152:167], v[60:63], v[44:47], v[152:167]
    ds_read_b64_tr_b16 v[92:93], v19 offset:20480
    s_waitcnt lgkmcnt(8)
    v_mfma_f32_16x16x32_bf16 v[30:33], v[68:71], v[26:29], v[30:33]
    v_mfma_f32_32x32x16_bf16 v[104:119], v[68:71], v[64:67], v[104:119]
    ds_read_b64_tr_b16 v[94:95], v19 offset:21504
    ds_read_b64_tr_b16 v[96:97], v20 offset:20480
    ds_read_b64_tr_b16 v[98:99], v20 offset:21504
    v_mfma_f32_32x32x16_bf16 v[120:135], v[72:75], v[64:67], v[120:135]
    ds_read_b64_tr_b16 v[100:101], v21 offset:20480
    ds_read_b64_tr_b16 v[102:103], v21 offset:21504
    ds_read_b64_tr_b16 v[48:49], v18 offset:24576
    s_waitcnt lgkmcnt(10)
    v_mfma_f32_32x32x16_bf16 v[136:151], v[76:79], v[64:67], v[136:151]
    ds_read_b64_tr_b16 v[50:51], v18 offset:25600
    ds_read_b128 v[44:47], v16 offset:16384
    ds_read_b64_tr_b16 v[52:53], v19 offset:24576
    v_mfma_f32_32x32x16_bf16 v[152:167], v[80:83], v[64:67], v[152:167]
    ds_read_b64_tr_b16 v[54:55], v19 offset:25600
    s_waitcnt lgkmcnt(9)
    v_mfma_f32_16x16x32_bf16 v[30:33], v[88:91], v[26:29], v[30:33]
    v_mfma_f32_32x32x16_bf16 v[104:119], v[88:91], v[84:87], v[104:119]
    ds_read_b32 v8, v6 offset:0
    ds_read_b64_tr_b16 v[56:57], v20 offset:24576
    ds_read_b64_tr_b16 v[58:59], v20 offset:25600
    ds_read_b64_tr_b16 v[60:61], v21 offset:24576
    v_mfma_f32_32x32x16_bf16 v[120:135], v[92:95], v[84:87], v[120:135]
    ds_read_b64_tr_b16 v[62:63], v21 offset:25600
    s_waitcnt lgkmcnt(10)
    v_mfma_f32_32x32x16_bf16 v[136:151], v[96:99], v[84:87], v[136:151]
    ds_read_b64_tr_b16 v[68:69], v18 offset:28672
    ds_read_b64_tr_b16 v[70:71], v18 offset:29696
    ds_read_b128 v[64:67], v17 offset:16384
    v_mfma_f32_32x32x16_bf16 v[152:167], v[100:103], v[84:87], v[152:167]
    s_waitcnt lgkmcnt(7)
    v_cmp_gt_u32 vcc, 3, v8
    s_cbranch_vccnz L_fs_128
L_fr_129:
    ds_read_b64_tr_b16 v[72:73], v19 offset:28672
    ds_read_b64_tr_b16 v[74:75], v19 offset:29696
    ds_read_b64_tr_b16 v[76:77], v20 offset:28672
    v_mfma_f32_16x16x32_bf16 v[30:33], v[48:51], v[26:29], v[30:33]
    v_mfma_f32_32x32x16_bf16 v[104:119], v[48:51], v[44:47], v[104:119]
    ds_read_b64_tr_b16 v[78:79], v20 offset:29696
    ds_read_b64_tr_b16 v[80:81], v21 offset:28672
    ds_read_b64_tr_b16 v[82:83], v21 offset:29696
    v_mfma_f32_32x32x16_bf16 v[120:135], v[52:55], v[44:47], v[120:135]
    v_mov_b32_e64 v12, 2
    ds_write_b32 v7, v12 offset:16
    s_waitcnt lgkmcnt(10)
    v_mfma_f32_32x32x16_bf16 v[136:151], v[56:59], v[44:47], v[136:151]
    ds_read_b64_tr_b16 v[88:89], v18 offset:32768
    ds_read_b64_tr_b16 v[90:91], v18 offset:33792
    ds_read_b128 v[84:87], v14 offset:32768
    v_mfma_f32_32x32x16_bf16 v[152:167], v[60:63], v[44:47], v[152:167]
    ds_read_b64_tr_b16 v[92:93], v19 offset:32768
    s_waitcnt lgkmcnt(9)
    v_mfma_f32_16x16x32_bf16 v[30:33], v[68:71], v[26:29], v[30:33]
    v_mfma_f32_32x32x16_bf16 v[104:119], v[68:71], v[64:67], v[104:119]
    ds_read_b64_tr_b16 v[94:95], v19 offset:33792
    ds_read_b64_tr_b16 v[96:97], v20 offset:32768
    ds_read_b64_tr_b16 v[98:99], v20 offset:33792
    v_mfma_f32_32x32x16_bf16 v[120:135], v[72:75], v[64:67], v[120:135]
    ds_read_b64_tr_b16 v[100:101], v21 offset:32768
    ds_read_b64_tr_b16 v[102:103], v21 offset:33792
    s_waitcnt lgkmcnt(10)
    v_mfma_f32_32x32x16_bf16 v[136:151], v[76:79], v[64:67], v[136:151]
    ds_read_b64_tr_b16 v[48:49], v18 offset:36864
    ds_read_b64_tr_b16 v[50:51], v18 offset:37888
    ds_read_b128 v[44:47], v15 offset:32768
    v_mfma_f32_32x32x16_bf16 v[152:167], v[80:83], v[64:67], v[152:167]
    ds_read_b64_tr_b16 v[52:53], v19 offset:36864
    s_waitcnt lgkmcnt(8)
    v_mfma_f32_16x16x32_bf16 v[30:33], v[88:91], v[26:29], v[30:33]
    v_mfma_f32_32x32x16_bf16 v[104:119], v[88:91], v[84:87], v[104:119]
    ds_read_b64_tr_b16 v[54:55], v19 offset:37888
    ds_read_b64_tr_b16 v[56:57], v20 offset:36864
    ds_read_b64_tr_b16 v[58:59], v20 offset:37888
    v_mfma_f32_32x32x16_bf16 v[120:135], v[92:95], v[84:87], v[120:135]
    ds_read_b64_tr_b16 v[60:61], v21 offset:36864
    ds_read_b64_tr_b16 v[62:63], v21 offset:37888
    ds_read_b64_tr_b16 v[68:69], v18 offset:40960
    s_waitcnt lgkmcnt(10)
    v_mfma_f32_32x32x16_bf16 v[136:151], v[96:99], v[84:87], v[136:151]
    ds_read_b64_tr_b16 v[70:71], v18 offset:41984
    ds_read_b128 v[64:67], v16 offset:32768
    ds_read_b64_tr_b16 v[72:73], v19 offset:40960
    v_mfma_f32_32x32x16_bf16 v[152:167], v[100:103], v[84:87], v[152:167]
    ds_read_b64_tr_b16 v[74:75], v19 offset:41984
    s_waitcnt lgkmcnt(9)
    v_mfma_f32_16x16x32_bf16 v[30:33], v[48:51], v[26:29], v[30:33]
    v_mfma_f32_32x32x16_bf16 v[104:119], v[48:51], v[44:47], v[104:119]
    ds_read_b32 v8, v6 offset:4
    ds_read_b64_tr_b16 v[76:77], v20 offset:40960
    ds_read_b64_tr_b16 v[78:79], v20 offset:41984
    ds_read_b64_tr_b16 v[80:81], v21 offset:40960
    v_mfma_f32_32x32x16_bf16 v[120:135], v[52:55], v[44:47], v[120:135]
    ds_read_b64_tr_b16 v[82:83], v21 offset:41984
    s_waitcnt lgkmcnt(10)
    v_mfma_f32_32x32x16_bf16 v[136:151], v[56:59], v[44:47], v[136:151]
    ds_read_b64_tr_b16 v[88:89], v18 offset:45056
    ds_read_b64_tr_b16 v[90:91], v18 offset:46080
    ds_read_b128 v[84:87], v17 offset:32768
    v_mfma_f32_32x32x16_bf16 v[152:167], v[60:63], v[44:47], v[152:167]
    s_waitcnt lgkmcnt(7)
    v_cmp_gt_u32 vcc, 4, v8
    s_cbranch_vccnz L_fs_131
L_fr_132:
    ds_read_b64_tr_b16 v[92:93], v19 offset:45056
    ds_read_b64_tr_b16 v[94:95], v19 offset:46080
    ds_read_b64_tr_b16 v[96:97], v20 offset:45056
    v_mfma_f32_16x16x32_bf16 v[30:33], v[68:71], v[26:29], v[30:33]
    v_mfma_f32_32x32x16_bf16 v[104:119], v[68:71], v[64:67], v[104:119]
    ds_read_b64_tr_b16 v[98:99], v20 offset:46080
    ds_read_b64_tr_b16 v[100:101], v21 offset:45056
    ds_read_b64_tr_b16 v[102:103], v21 offset:46080
    v_mfma_f32_32x32x16_bf16 v[120:135], v[72:75], v[64:67], v[120:135]
    v_mov_b32_e64 v12, 3
    ds_write_b32 v7, v12 offset:16
    s_waitcnt lgkmcnt(10)
    v_mfma_f32_32x32x16_bf16 v[136:151], v[76:79], v[64:67], v[136:151]
    ds_read_b64_tr_b16 v[48:49], v18 offset:49152
    ds_read_b64_tr_b16 v[50:51], v18 offset:50176
    ds_read_b128 v[44:47], v14 offset:49152
    v_mfma_f32_32x32x16_bf16 v[152:167], v[80:83], v[64:67], v[152:167]
    ds_read_b64_tr_b16 v[52:53], v19 offset:49152
    s_waitcnt lgkmcnt(9)
    v_mfma_f32_16x16x32_bf16 v[30:33], v[88:91], v[26:29], v[30:33]
    v_mfma_f32_32x32x16_bf16 v[104:119], v[88:91], v[84:87], v[104:119]
    ds_read_b64_tr_b16 v[54:55], v19 offset:50176
    ds_read_b64_tr_b16 v[56:57], v20 offset:49152
    ds_read_b64_tr_b16 v[58:59], v20 offset:50176
    v_mfma_f32_32x32x16_bf16 v[120:135], v[92:95], v[84:87], v[120:135]
    ds_read_b64_tr_b16 v[60:61], v21 offset:49152
    ds_read_b64_tr_b16 v[62:63], v21 offset:50176
    s_waitcnt lgkmcnt(10)
    v_mfma_f32_32x32x16_bf16 v[136:151], v[96:99], v[84:87], v[136:151]
    ds_read_b64_tr_b16 v[68:69], v18 offset:53248
    ds_read_b64_tr_b16 v[70:71], v18 offset:54272
    ds_read_b128 v[64:67], v15 offset:49152
    v_mfma_f32_32x32x16_bf16 v[152:167], v[100:103], v[84:87], v[152:167]
    ds_read_b64_tr_b16 v[72:73], v19 offset:53248
    s_waitcnt lgkmcnt(8)
    v_mfma_f32_16x16x32_bf16 v[30:33], v[48:51], v[26:29], v[30:33]
    v_mfma_f32_32x32x16_bf16 v[104:119], v[48:51], v[44:47], v[104:119]
    ds_read_b64_tr_b16 v[74:75], v19 offset:54272
    ds_read_b64_tr_b16 v[76:77], v20 offset:53248
    ds_read_b64_tr_b16 v[78:79], v20 offset:54272
    v_mfma_f32_32x32x16_bf16 v[120:135], v[52:55], v[44:47], v[120:135]
    ds_read_b64_tr_b16 v[80:81], v21 offset:53248
    ds_read_b64_tr_b16 v[82:83], v21 offset:54272
    ds_read_b64_tr_b16 v[88:89], v18 offset:57344
    s_waitcnt lgkmcnt(10)
    v_mfma_f32_32x32x16_bf16 v[136:151], v[56:59], v[44:47], v[136:151]
    ds_read_b64_tr_b16 v[90:91], v18 offset:58368
    ds_read_b128 v[84:87], v16 offset:49152
    ds_read_b64_tr_b16 v[92:93], v19 offset:57344
    v_mfma_f32_32x32x16_bf16 v[152:167], v[60:63], v[44:47], v[152:167]
    ds_read_b64_tr_b16 v[94:95], v19 offset:58368
    s_waitcnt lgkmcnt(9)
    v_mfma_f32_16x16x32_bf16 v[30:33], v[68:71], v[26:29], v[30:33]
    v_mfma_f32_32x32x16_bf16 v[104:119], v[68:71], v[64:67], v[104:119]
    ds_read_b32 v8, v6 offset:0
    ds_read_b64_tr_b16 v[96:97], v20 offset:57344
    ds_read_b64_tr_b16 v[98:99], v20 offset:58368
    ds_read_b64_tr_b16 v[100:101], v21 offset:57344
    v_mfma_f32_32x32x16_bf16 v[120:135], v[72:75], v[64:67], v[120:135]
    ds_read_b64_tr_b16 v[102:103], v21 offset:58368
    s_waitcnt lgkmcnt(10)
    v_mfma_f32_32x32x16_bf16 v[136:151], v[76:79], v[64:67], v[136:151]
    ds_read_b64_tr_b16 v[48:49], v18 offset:61440
    ds_read_b64_tr_b16 v[50:51], v18 offset:62464
    ds_read_b128 v[44:47], v17 offset:49152
    v_mfma_f32_32x32x16_bf16 v[152:167], v[80:83], v[64:67], v[152:167]
    s_waitcnt lgkmcnt(7)
    v_cmp_gt_u32 vcc, 5, v8
    s_cbranch_vccnz L_fs_134
L_fr_135:
    ds_read_b64_tr_b16 v[52:53], v19 offset:61440
    ds_read_b64_tr_b16 v[54:55], v19 offset:62464
    ds_read_b64_tr_b16 v[56:57], v20 offset:61440
    v_mfma_f32_16x16x32_bf16 v[30:33], v[88:91], v[26:29], v[30:33]
    v_mfma_f32_32x32x16_bf16 v[104:119], v[88:91], v[84:87], v[104:119]
    ds_read_b64_tr_b16 v[58:59], v20 offset:62464
    ds_read_b64_tr_b16 v[60:61], v21 offset:61440
    ds_read_b64_tr_b16 v[62:63], v21 offset:62464
    v_mfma_f32_32x32x16_bf16 v[120:135], v[92:95], v[84:87], v[120:135]
    v_mov_b32_e64 v12, 4
    ds_write_b32 v7, v12 offset:16
    s_waitcnt lgkmcnt(10)
    v_mfma_f32_32x32x16_bf16 v[136:151], v[96:99], v[84:87], v[136:151]
    ds_read_b64_tr_b16 v[68:69], v18 offset:0
    ds_read_b64_tr_b16 v[70:71], v18 offset:1024
    ds_read_b128 v[64:67], v14 offset:0
    v_mfma_f32_32x32x16_bf16 v[152:167], v[100:103], v[84:87], v[152:167]
    ds_read_b64_tr_b16 v[72:73], v19 offset:0
    s_waitcnt lgkmcnt(9)
    v_mfma_f32_16x16x32_bf16 v[30:33], v[48:51], v[26:29], v[30:33]
    v_mfma_f32_32x32x16_bf16 v[104:119], v[48:51], v[44:47], v[104:119]
    ds_read_b64_tr_b16 v[74:75], v19 offset:1024
    ds_read_b64_tr_b16 v[76:77], v20 offset:0
    ds_read_b64_tr_b16 v[78:79], v20 offset:1024
    v_mfma_f32_32x32x16_bf16 v[120:135], v[52:55], v[44:47], v[120:135]
    ds_read_b64_tr_b16 v[80:81], v21 offset:0
    ds_read_b64_tr_b16 v[82:83], v21 offset:1024
    s_waitcnt lgkmcnt(10)
    v_mfma_f32_32x32x16_bf16 v[136:151], v[56:59], v[44:47], v[136:151]
    ds_read_b64_tr_b16 v[88:89], v18 offset:4096
    ds_read_b64_tr_b16 v[90:91], v18 offset:5120
    ds_read_b128 v[84:87], v15 offset:0
    v_mfma_f32_32x32x16_bf16 v[152:167], v[60:63], v[44:47], v[152:167]
    ds_read_b64_tr_b16 v[92:93], v19 offset:4096
    s_waitcnt lgkmcnt(8)
    v_mfma_f32_16x16x32_bf16 v[30:33], v[68:71], v[26:29], v[30:33]
    v_mfma_f32_32x32x16_bf16 v[104:119], v[68:71], v[64:67], v[104:119]
    ds_read_b64_tr_b16 v[94:95], v19 offset:5120
    ds_read_b64_tr_b16 v[96:97], v20 offset:4096
    ds_read_b64_tr_b16 v[98:99], v20 offset:5120
    v_mfma_f32_32x32x16_bf16 v[120:135], v[72:75], v[64:67], v[120:135]
    ds_read_b64_tr_b16 v[100:101], v21 offset:4096
    ds_read_b64_tr_b16 v[102:103], v21 offset:5120
    ds_read_b64_tr_b16 v[48:49], v18 offset:8192
    s_waitcnt lgkmcnt(10)
    v_mfma_f32_32x32x16_bf16 v[136:151], v[76:79], v[64:67], v[136:151]
    ds_read_b64_tr_b16 v[50:51], v18 offset:9216
    ds_read_b128 v[44:47], v16 offset:0
    ds_read_b64_tr_b16 v[52:53], v19 offset:8192
    v_mfma_f32_32x32x16_bf16 v[152:167], v[80:83], v[64:67], v[152:167]
    ds_read_b64_tr_b16 v[54:55], v19 offset:9216
    s_waitcnt lgkmcnt(9)
    v_mfma_f32_16x16x32_bf16 v[30:33], v[88:91], v[26:29], v[30:33]
    v_mfma_f32_32x32x16_bf16 v[104:119], v[88:91], v[84:87], v[104:119]
    ds_read_b32 v8, v6 offset:4
    ds_read_b64_tr_b16 v[56:57], v20 offset:8192
    ds_read_b64_tr_b16 v[58:59], v20 offset:9216
    ds_read_b64_tr_b16 v[60:61], v21 offset:8192
    v_mfma_f32_32x32x16_bf16 v[120:135], v[92:95], v[84:87], v[120:135]
    ds_read_b64_tr_b16 v[62:63], v21 offset:9216
    s_waitcnt lgkmcnt(10)
    v_mfma_f32_32x32x16_bf16 v[136:151], v[96:99], v[84:87], v[136:151]
    ds_read_b64_tr_b16 v[68:69], v18 offset:12288
    ds_read_b64_tr_b16 v[70:71], v18 offset:13312
    ds_read_b128 v[64:67], v17 offset:0
    v_mfma_f32_32x32x16_bf16 v[152:167], v[100:103], v[84:87], v[152:167]
    s_waitcnt lgkmcnt(7)
    v_cmp_gt_u32 vcc, 6, v8
    s_cbranch_vccnz L_fs_137
L_fr_138:
    ds_read_b64_tr_b16 v[72:73], v19 offset:12288
    ds_read_b64_tr_b16 v[74:75], v19 offset:13312
    ds_read_b64_tr_b16 v[76:77], v20 offset:12288
    v_mfma_f32_16x16x32_bf16 v[30:33], v[48:51], v[26:29], v[30:33]
    v_mfma_f32_32x32x16_bf16 v[104:119], v[48:51], v[44:47], v[104:119]
    ds_read_b64_tr_b16 v[78:79], v20 offset:13312
    ds_read_b64_tr_b16 v[80:81], v21 offset:12288
    ds_read_b64_tr_b16 v[82:83], v21 offset:13312
    v_mfma_f32_32x32x16_bf16 v[120:135], v[52:55], v[44:47], v[120:135]
    v_mov_b32_e64 v12, 5
    ds_write_b32 v7, v12 offset:16
    s_waitcnt lgkmcnt(10)
    v_mfma_f32_32x32x16_bf16 v[136:151], v[56:59], v[44:47], v[136:151]
    ds_read_b64_tr_b16 v[88:89], v18 offset:16384
    ds_read_b64_tr_b16 v[90:91], v18 offset:17408
    ds_read_b128 v[84:87], v14 offset:16384
    v_mfma_f32_32x32x16_bf16 v[152:167], v[60:63], v[44:47], v[152:167]
    ds_read_b64_tr_b16 v[92:93], v19 offset:16384
    s_waitcnt lgkmcnt(9)
    v_mfma_f32_16x16x32_bf16 v[30:33], v[68:71], v[26:29], v[30:33]
    v_mfma_f32_32x32x16_bf16 v[104:119], v[68:71], v[64:67], v[104:119]
    ds_read_b64_tr_b16 v[94:95], v19 offset:17408
    ds_read_b64_tr_b16 v[96:97], v20 offset:16384
    ds_read_b64_tr_b16 v[98:99], v20 offset:17408
    v_mfma_f32_32x32x16_bf16 v[120:135], v[72:75], v[64:67], v[120:135]
    ds_read_b64_tr_b16 v[100:101], v21 offset:16384
    ds_read_b64_tr_b16 v[102:103], v21 offset:17408
    s_waitcnt lgkmcnt(10)
    v_mfma_f32_32x32x16_bf16 v[136:151], v[76:79], v[64:67], v[136:151]
    ds_read_b64_tr_b16 v[48:49], v18 offset:20480
    ds_read_b64_tr_b16 v[50:51], v18 offset:21504
    ds_read_b128 v[44:47], v15 offset:16384
    v_mfma_f32_32x32x16_bf16 v[152:167], v[80:83], v[64:67], v[152:167]
    ds_read_b64_tr_b16 v[52:53], v19 offset:20480
    s_waitcnt lgkmcnt(8)
    v_mfma_f32_16x16x32_bf16 v[30:33], v[88:91], v[26:29], v[30:33]
    v_mfma_f32_32x32x16_bf16 v[104:119], v[88:91], v[84:87], v[104:119]
    ds_read_b64_tr_b16 v[54:55], v19 offset:21504
    ds_read_b64_tr_b16 v[56:57], v20 offset:20480
    ds_read_b64_tr_b16 v[58:59], v20 offset:21504
    v_mfma_f32_32x32x16_bf16 v[120:135], v[92:95], v[84:87], v[120:135]
    ds_read_b64_tr_b16 v[60:61], v21 offset:20480
    ds_read_b64_tr_b16 v[62:63], v21 offset:21504
    ds_read_b64_tr_b16 v[68:69], v18 offset:24576
    s_waitcnt lgkmcnt(10)
    v_mfma_f32_32x32x16_bf16 v[136:151], v[96:99], v[84:87], v[136:151]
    ds_read_b64_tr_b16 v[70:71], v18 offset:25600
    ds_read_b128 v[64:67], v16 offset:16384
    ds_read_b64_tr_b16 v[72:73], v19 offset:24576
    v_mfma_f32_32x32x16_bf16 v[152:167], v[100:103], v[84:87], v[152:167]
    ds_read_b64_tr_b16 v[74:75], v19 offset:25600
    s_waitcnt lgkmcnt(9)
    v_mfma_f32_16x16x32_bf16 v[30:33], v[48:51], v[26:29], v[30:33]
    v_mfma_f32_32x32x16_bf16 v[104:119], v[48:51], v[44:47], v[104:119]
    ds_read_b32 v8, v6 offset:0
    ds_read_b64_tr_b16 v[76:77], v20 offset:24576
    ds_read_b64_tr_b16 v[78:79], v20 offset:25600
    ds_read_b64_tr_b16 v[80:81], v21 offset:24576
    v_mfma_f32_32x32x16_bf16 v[120:135], v[52:55], v[44:47], v[120:135]
    ds_read_b64_tr_b16 v[82:83], v21 offset:25600
    s_waitcnt lgkmcnt(10)
    v_mfma_f32_32x32x16_bf16 v[136:151], v[56:59], v[44:47], v[136:151]
    ds_read_b64_tr_b16 v[88:89], v18 offset:28672
    ds_read_b64_tr_b16 v[90:91], v18 offset:29696
    ds_read_b128 v[84:87], v17 offset:16384
    v_mfma_f32_32x32x16_bf16 v[152:167], v[60:63], v[44:47], v[152:167]
    s_waitcnt lgkmcnt(7)
    v_cmp_gt_u32 vcc, 7, v8
    s_cbranch_vccnz L_fs_140
L_fr_141:
    ds_read_b64_tr_b16 v[92:93], v19 offset:28672
    ds_read_b64_tr_b16 v[94:95], v19 offset:29696
    ds_read_b64_tr_b16 v[96:97], v20 offset:28672
    v_mfma_f32_16x16x32_bf16 v[30:33], v[68:71], v[26:29], v[30:33]
    v_mfma_f32_32x32x16_bf16 v[104:119], v[68:71], v[64:67], v[104:119]
    ds_read_b64_tr_b16 v[98:99], v20 offset:29696
    ds_read_b64_tr_b16 v[100:101], v21 offset:28672
    ds_read_b64_tr_b16 v[102:103], v21 offset:29696
    v_mfma_f32_32x32x16_bf16 v[120:135], v[72:75], v[64:67], v[120:135]
    v_mov_b32_e64 v12, 6
    ds_write_b32 v7, v12 offset:16
    s_waitcnt lgkmcnt(10)
    v_mfma_f32_32x32x16_bf16 v[136:151], v[76:79], v[64:67], v[136:151]
    ds_read_b64_tr_b16 v[48:49], v18 offset:32768
    ds_read_b64_tr_b16 v[50:51], v18 offset:33792
    ds_read_b128 v[44:47], v14 offset:32768
    v_mfma_f32_32x32x16_bf16 v[152:167], v[80:83], v[64:67], v[152:167]
    ds_read_b64_tr_b16 v[52:53], v19 offset:32768
    s_waitcnt lgkmcnt(9)
    v_mfma_f32_16x16x32_bf16 v[30:33], v[88:91], v[26:29], v[30:33]
    v_mfma_f32_32x32x16_bf16 v[104:119], v[88:91], v[84:87], v[104:119]
    ds_read_b64_tr_b16 v[54:55], v19 offset:33792
    ds_read_b64_tr_b16 v[56:57], v20 offset:32768
    ds_read_b64_tr_b16 v[58:59], v20 offset:33792
    v_mfma_f32_32x32x16_bf16 v[120:135], v[92:95], v[84:87], v[120:135]
    ds_read_b64_tr_b16 v[60:61], v21 offset:32768
    ds_read_b64_tr_b16 v[62:63], v21 offset:33792
    s_waitcnt lgkmcnt(10)
    v_mfma_f32_32x32x16_bf16 v[136:151], v[96:99], v[84:87], v[136:151]
    ds_read_b64_tr_b16 v[68:69], v18 offset:36864
    ds_read_b64_tr_b16 v[70:71], v18 offset:37888
    ds_read_b128 v[64:67], v15 offset:32768
    v_mfma_f32_32x32x16_bf16 v[152:167], v[100:103], v[84:87], v[152:167]
    ds_read_b64_tr_b16 v[72:73], v19 offset:36864
    s_waitcnt lgkmcnt(8)
    v_mfma_f32_16x16x32_bf16 v[30:33], v[48:51], v[26:29], v[30:33]
    v_mfma_f32_32x32x16_bf16 v[104:119], v[48:51], v[44:47], v[104:119]
    ds_read_b64_tr_b16 v[74:75], v19 offset:37888
    ds_read_b64_tr_b16 v[76:77], v20 offset:36864
    ds_read_b64_tr_b16 v[78:79], v20 offset:37888
    v_mfma_f32_32x32x16_bf16 v[120:135], v[52:55], v[44:47], v[120:135]
    ds_read_b64_tr_b16 v[80:81], v21 offset:36864
    ds_read_b64_tr_b16 v[82:83], v21 offset:37888
    ds_read_b64_tr_b16 v[88:89], v18 offset:40960
    s_waitcnt lgkmcnt(10)
    v_mfma_f32_32x32x16_bf16 v[136:151], v[56:59], v[44:47], v[136:151]
    ds_read_b64_tr_b16 v[90:91], v18 offset:41984
    ds_read_b128 v[84:87], v16 offset:32768
    ds_read_b64_tr_b16 v[92:93], v19 offset:40960
    v_mfma_f32_32x32x16_bf16 v[152:167], v[60:63], v[44:47], v[152:167]
    ds_read_b64_tr_b16 v[94:95], v19 offset:41984
    s_waitcnt lgkmcnt(9)
    v_mfma_f32_16x16x32_bf16 v[30:33], v[68:71], v[26:29], v[30:33]
    v_mfma_f32_32x32x16_bf16 v[104:119], v[68:71], v[64:67], v[104:119]
    ds_read_b32 v8, v6 offset:4
    ds_read_b64_tr_b16 v[96:97], v20 offset:40960
    ds_read_b64_tr_b16 v[98:99], v20 offset:41984
    ds_read_b64_tr_b16 v[100:101], v21 offset:40960
    v_mfma_f32_32x32x16_bf16 v[120:135], v[72:75], v[64:67], v[120:135]
    ds_read_b64_tr_b16 v[102:103], v21 offset:41984
    s_waitcnt lgkmcnt(10)
    v_mfma_f32_32x32x16_bf16 v[136:151], v[76:79], v[64:67], v[136:151]
    ds_read_b64_tr_b16 v[48:49], v18 offset:45056
    ds_read_b64_tr_b16 v[50:51], v18 offset:46080
    ds_read_b128 v[44:47], v17 offset:32768
    v_mfma_f32_32x32x16_bf16 v[152:167], v[80:83], v[64:67], v[152:167]
    s_waitcnt lgkmcnt(7)
    v_cmp_gt_u32 vcc, 8, v8
    s_cbranch_vccnz L_fs_143
L_fr_144:
    ds_read_b64_tr_b16 v[52:53], v19 offset:45056
    ds_read_b64_tr_b16 v[54:55], v19 offset:46080
    ds_read_b64_tr_b16 v[56:57], v20 offset:45056
    v_mfma_f32_16x16x32_bf16 v[30:33], v[88:91], v[26:29], v[30:33]
    v_mfma_f32_32x32x16_bf16 v[104:119], v[88:91], v[84:87], v[104:119]
    ds_read_b64_tr_b16 v[58:59], v20 offset:46080
    ds_read_b64_tr_b16 v[60:61], v21 offset:45056
    ds_read_b64_tr_b16 v[62:63], v21 offset:46080
    v_mfma_f32_32x32x16_bf16 v[120:135], v[92:95], v[84:87], v[120:135]
    v_mov_b32_e64 v12, 7
    ds_write_b32 v7, v12 offset:16
    s_waitcnt lgkmcnt(10)
    v_mfma_f32_32x32x16_bf16 v[136:151], v[96:99], v[84:87], v[136:151]
    ds_read_b64_tr_b16 v[68:69], v18 offset:49152
    ds_read_b64_tr_b16 v[70:71], v18 offset:50176
    ds_read_b128 v[64:67], v14 offset:49152
    v_mfma_f32_32x32x16_bf16 v[152:167], v[100:103], v[84:87], v[152:167]
    ds_read_b64_tr_b16 v[72:73], v19 offset:49152
    s_waitcnt lgkmcnt(9)
    v_mfma_f32_16x16x32_bf16 v[30:33], v[48:51], v[26:29], v[30:33]
    v_mfma_f32_32x32x16_bf16 v[104:119], v[48:51], v[44:47], v[104:119]
    ds_read_b64_tr_b16 v[74:75], v19 offset:50176
    ds_read_b64_tr_b16 v[76:77], v20 offset:49152
    ds_read_b64_tr_b16 v[78:79], v20 offset:50176
    v_mfma_f32_32x32x16_bf16 v[120:135], v[52:55], v[44:47], v[120:135]
    ds_read_b64_tr_b16 v[80:81], v21 offset:49152
    ds_read_b64_tr_b16 v[82:83], v21 offset:50176
    s_waitcnt lgkmcnt(10)
    v_mfma_f32_32x32x16_bf16 v[136:151], v[56:59], v[44:47], v[136:151]
    ds_read_b64_tr_b16 v[88:89], v18 offset:53248
    ds_read_b64_tr_b16 v[90:91], v18 offset:54272
    ds_read_b128 v[84:87], v15 offset:49152
    v_mfma_f32_32x32x16_bf16 v[152:167], v[60:63], v[44:47], v[152:167]
    ds_read_b64_tr_b16 v[92:93], v19 offset:53248
    s_waitcnt lgkmcnt(8)
    v_mfma_f32_16x16x32_bf16 v[30:33], v[68:71], v[26:29], v[30:33]
    v_mfma_f32_32x32x16_bf16 v[104:119], v[68:71], v[64:67], v[104:119]
    ds_read_b64_tr_b16 v[94:95], v19 offset:54272
    ds_read_b64_tr_b16 v[96:97], v20 offset:53248
    ds_read_b64_tr_b16 v[98:99], v20 offset:54272
    v_mfma_f32_32x32x16_bf16 v[120:135], v[72:75], v[64:67], v[120:135]
    ds_read_b64_tr_b16 v[100:101], v21 offset:53248
    ds_read_b64_tr_b16 v[102:103], v21 offset:54272
    ds_read_b64_tr_b16 v[48:49], v18 offset:57344
    s_waitcnt lgkmcnt(10)
    v_mfma_f32_32x32x16_bf16 v[136:151], v[76:79], v[64:67], v[136:151]
    ds_read_b64_tr_b16 v[50:51], v18 offset:58368
    ds_read_b128 v[44:47], v16 offset:49152
    ds_read_b64_tr_b16 v[52:53], v19 offset:57344
    v_mfma_f32_32x32x16_bf16 v[152:167], v[80:83], v[64:67], v[152:167]
    ds_read_b64_tr_b16 v[54:55], v19 offset:58368
    s_waitcnt lgkmcnt(9)
    v_mfma_f32_16x16x32_bf16 v[30:33], v[88:91], v[26:29], v[30:33]
    v_mfma_f32_32x32x16_bf16 v[104:119], v[88:91], v[84:87], v[104:119]
    ds_read_b64_tr_b16 v[56:57], v20 offset:57344
    ds_read_b64_tr_b16 v[58:59], v20 offset:58368
    ds_read_b64_tr_b16 v[60:61], v21 offset:57344
    v_mfma_f32_32x32x16_bf16 v[120:135], v[92:95], v[84:87], v[120:135]
    ds_read_b64_tr_b16 v[62:63], v21 offset:58368
    ds_read_b64_tr_b16 v[68:69], v18 offset:61440
    s_waitcnt lgkmcnt(10)
    v_mfma_f32_32x32x16_bf16 v[136:151], v[96:99], v[84:87], v[136:151]
    ds_read_b64_tr_b16 v[70:71], v18 offset:62464
    ds_read_b128 v[64:67], v17 offset:49152
    ds_read_b64_tr_b16 v[72:73], v19 offset:61440
    v_mfma_f32_32x32x16_bf16 v[152:167], v[100:103], v[84:87], v[152:167]
    ds_read_b64_tr_b16 v[74:75], v19 offset:62464
    s_waitcnt lgkmcnt(9)
    v_mfma_f32_16x16x32_bf16 v[30:33], v[48:51], v[26:29], v[30:33]
    v_mfma_f32_32x32x16_bf16 v[104:119], v[48:51], v[44:47], v[104:119]
    ds_read_b64_tr_b16 v[76:77], v20 offset:61440
    ds_read_b64_tr_b16 v[78:79], v20 offset:62464
    ds_read_b64_tr_b16 v[80:81], v21 offset:61440
    v_mfma_f32_32x32x16_bf16 v[120:135], v[52:55], v[44:47], v[120:135]
    ds_read_b64_tr_b16 v[82:83], v21 offset:62464
    v_mov_b32_e64 v12, 8
    ds_write_b32 v7, v12 offset:16
    s_waitcnt lgkmcnt(10)
    v_mfma_f32_32x32x16_bf16 v[136:151], v[56:59], v[44:47], v[136:151]
    ds_read_b32 v8, v6 offset:112
    v_mfma_f32_32x32x16_bf16 v[152:167], v[60:63], v[44:47], v[152:167]
    s_waitcnt lgkmcnt(6)
    v_mfma_f32_16x16x32_bf16 v[30:33], v[68:71], v[26:29], v[30:33]
    v_mfma_f32_32x32x16_bf16 v[104:119], v[68:71], v[64:67], v[104:119]
    s_waitcnt lgkmcnt(0)
    v_cmp_gt_u32 vcc, 1, v8
    s_cbranch_vccnz L_fs_146
L_fr_147:
    ds_read_b128 v[34:37], v40
    v_mfma_f32_32x32x16_bf16 v[120:135], v[72:75], v[64:67], v[120:135]
    s_nop 1
    ds_write_b128 v41, v[30:33]
    v_mov_b32_e64 v12, 1
    ds_write_b32 v7, v12 offset:64
    v_mfma_f32_32x32x16_bf16 v[136:151], v[76:79], v[64:67], v[136:151]
    v_mfma_f32_32x32x16_bf16 v[152:167], v[80:83], v[64:67], v[152:167]
    ds_read_b128 v[8:11], v6 offset:64
    s_waitcnt lgkmcnt(3)
    v_cmp_ne_u32 vcc, s56, v36
    s_cbranch_vccnz L_poll_149
L_pok_150:
    v_lshlrev_b32 v15, 16, v34
    v_and_b32 v34, s63, v34
    v_lshlrev_b32 v36, 16, v35
    v_and_b32 v35, s63, v35
    v_mul_f32 v14, v34, v35
    v_rcp_f32_e64 v14, v14
    v_fmac_f32 v15, v36, v34
    s_waitcnt lgkmcnt(0)
    v_min3_u32 v8, v8, v9, v10
    v_min_u32_e64 v8, v8, v11
    v_cmp_gt_u32 vcc, 1, v8
    s_cbranch_vccnz L_fs_152
L_fr_153:
    ds_read_b128 v[44:47], v22 offset:0
    ds_read_b128 v[86:89], v22 offset:512
    ds_read_b128 v[48:51], v22 offset:32
    ds_read_b128 v[90:93], v22 offset:544
    ds_read_b128 v[52:55], v22 offset:64
    ds_read_b128 v[94:97], v22 offset:576
    ds_read_b128 v[56:59], v22 offset:96
    ds_read_b128 v[98:101], v22 offset:608
    v_mul_f32_e64 v16, -v15, v14
    v_mov_b32 v15, v14
    v_mov_b32_e64 v17, v16
    s_waitcnt lgkmcnt(6)
    v_pk_fma_f32 v[66:67], v[44:45], v[16:17], v[86:87]
    v_pk_fma_f32 v[68:69], v[46:47], v[16:17], v[88:89]
    v_pk_fma_f32 v[104:105], v[104:105], v[14:15], v[66:67]
    v_pk_fma_f32 v[106:107], v[106:107], v[14:15], v[68:69]
    s_waitcnt lgkmcnt(4)
    s_nop 0
    v_pk_fma_f32 v[70:71], v[48:49], v[16:17], v[90:91]
    v_pk_fma_f32 v[72:73], v[50:51], v[16:17], v[92:93]
    v_pk_fma_f32 v[108:109], v[108:109], v[14:15], v[70:71]
    v_pk_fma_f32 v[110:111], v[110:111], v[14:15], v[72:73]
    s_waitcnt lgkmcnt(2)
    s_nop 0
    v_pk_fma_f32 v[74:75], v[52:53], v[16:17], v[94:95]
    v_pk_fma_f32 v[76:77], v[54:55], v[16:17], v[96:97]
    v_pk_fma_f32 v[112:113], v[112:113], v[14:15], v[74:75]
    v_pk_fma_f32 v[114:115], v[114:115], v[14:15], v[76:77]
    s_waitcnt lgkmcnt(0)
    s_nop 0
    v_pk_fma_f32 v[78:79], v[56:57], v[16:17], v[98:99]
    v_pk_fma_f32 v[80:81], v[58:59], v[16:17], v[100:101]
    v_pk_fma_f32 v[116:117], v[116:117], v[14:15], v[78:79]
    v_pk_fma_f32 v[118:119], v[118:119], v[14:15], v[80:81]
    ds_read_b128 v[44:47], v23 offset:0
    ds_read_b128 v[86:89], v23 offset:512
    ds_read_b128 v[48:51], v23 offset:32
    ds_read_b128 v[90:93], v23 offset:544
    ds_read_b128 v[52:55], v23 offset:64
    ds_read_b128 v[94:97], v23 offset:576
    ds_read_b128 v[56:59], v23 offset:96
    ds_read_b128 v[98:101], v23 offset:608
    s_cmp_ge_u32 s12, 0x7ff00000
    s_cbranch_scc1 L_skt0
    s_nop 0
    v_pk_mul_f32 v[66:67], v[104:105], v[104:105]
    v_pk_mul_f32 v[68:69], v[106:107], v[106:107]
    v_pk_mul_f32 v[70:71], v[108:109], v[108:109]
    v_pk_mul_f32 v[72:73], v[110:111], v[110:111]
    v_pk_mul_f32 v[74:75], v[112:113], v[112:113]
    v_pk_mul_f32 v[76:77], v[114:115], v[114:115]
    v_pk_mul_f32 v[78:79], v[116:117], v[116:117]
    v_pk_mul_f32 v[80:81], v[118:119], v[118:119]
    v_pk_fma_f32 v[66:67], v[66:67], s[18:19], v[42:43]
    v_pk_fma_f32 v[68:69], v[68:69], s[18:19], v[42:43]
    v_pk_fma_f32 v[70:71], v[70:71], s[18:19], v[42:43]
    v_pk_fma_f32 v[72:73], v[72:73], s[18:19], v[42:43]
    v_pk_fma_f32 v[74:75], v[74:75], s[18:19], v[42:43]
    v_pk_fma_f32 v[76:77], v[76:77], s[18:19], v[42:43]
    v_pk_fma_f32 v[78:79], v[78:79], s[18:19], v[42:43]
    v_pk_fma_f32 v[80:81], v[80:81], s[18:19], v[42:43]
    v_pk_mul_f32 v[66:67], v[66:67], v[104:105]
    v_pk_mul_f32 v[68:69], v[68:69], v[106:107]
    v_pk_mul_f32 v[70:71], v[70:71], v[108:109]
    v_pk_mul_f32 v[72:73], v[72:73], v[110:111]
    v_pk_mul_f32 v[74:75], v[74:75], v[112:113]
    v_pk_mul_f32 v[76:77], v[76:77], v[114:115]
    v_pk_mul_f32 v[78:79], v[78:79], v[116:117]
    v_pk_mul_f32 v[80:81], v[80:81], v[118:119]
    v_exp_f32 v66, v66
    v_exp_f32 v67, v67
    v_exp_f32 v68, v68
    v_exp_f32 v69, v69
    v_exp_f32 v70, v70
    v_exp_f32 v71, v71
    v_exp_f32 v72, v72
    v_exp_f32 v73, v73
    v_exp_f32 v74, v74
    v_exp_f32 v75, v75
    v_exp_f32 v76, v76
    v_exp_f32 v77, v77
    v_exp_f32 v78, v78
    v_exp_f32 v79, v79
    v_exp_f32 v80, v80
    v_exp_f32 v81, v81
    v_pk_add_f32 v[66:67], v[66:67], 1.0 op_sel_hi:[1,0]
    v_pk_add_f32 v[68:69], v[68:69], 1.0 op_sel_hi:[1,0]
    v_pk_add_f32 v[70:71], v[70:71], 1.0 op_sel_hi:[1,0]
    v_pk_add_f32 v[72:73], v[72:73], 1.0 op_sel_hi:[1,0]
    v_pk_add_f32 v[74:75], v[74:75], 1.0 op_sel_hi:[1,0]
    v_pk_add_f32 v[76:77], v[76:77], 1.0 op_sel_hi:[1,0]
    v_pk_add_f32 v[78:79], v[78:79], 1.0 op_sel_hi:[1,0]
    v_pk_add_f32 v[80:81], v[80:81], 1.0 op_sel_hi:[1,0]
    v_rcp_f32 v66, v66
    v_rcp_f32 v67, v67
    v_rcp_f32 v68, v68
    v_rcp_f32 v69, v69
    v_rcp_f32 v70, v70
    v_rcp_f32 v71, v71
    v_rcp_f32 v72, v72
    v_rcp_f32 v73, v73
    v_rcp_f32 v74, v74
    v_rcp_f32 v75, v75
    v_rcp_f32 v76, v76
    v_rcp_f32 v77, v77
    v_rcp_f32 v78, v78
    v_rcp_f32 v79, v79
    v_rcp_f32 v80, v80
    v_rcp_f32 v81, v81
    v_pk_mul_f32 v[66:67], v[66:67], v[104:105]
    v_pk_mul_f32 v[68:69], v[68:69], v[106:107]
    v_pk_mul_f32 v[70:71], v[70:71], v[108:109]
    v_pk_mul_f32 v[72:73], v[72:73], v[110:111]
    v_pk_mul_f32 v[74:75], v[74:75], v[112:113]
    v_pk_mul_f32 v[76:77], v[76:77], v[114:115]
    v_pk_mul_f32 v[78:79], v[78:79], v[116:117]
    v_pk_mul_f32 v[80:81], v[80:81], v[118:119]
    v_cvt_pk_bf16_f32 v104, v66, v67
    v_cvt_pk_bf16_f32 v105, v68, v69
    v_cvt_pk_bf16_f32 v106, v70, v71
    v_cvt_pk_bf16_f32 v107, v72, v73
    v_cvt_pk_bf16_f32 v108, v74, v75
    v_cvt_pk_bf16_f32 v109, v76, v77
    v_cvt_pk_bf16_f32 v110, v78, v79
    v_cvt_pk_bf16_f32 v111, v80, v81
    buffer_store_dwordx4 v[104:107], v38, s[52:55], s12 offen sc1
    buffer_store_dwordx4 v[108:111], v38, s[52:55], s12 offen offset:512 sc1
L_skt0:
    s_waitcnt lgkmcnt(6)
    s_nop 0
    v_pk_fma_f32 v[66:67], v[44:45], v[16:17], v[86:87]
    v_pk_fma_f32 v[68:69], v[46:47], v[16:17], v[88:89]
    v_pk_fma_f32 v[120:121], v[120:121], v[14:15], v[66:67]
    v_pk_fma_f32 v[122:123], v[122:123], v[14:15], v[68:69]
    s_waitcnt lgkmcnt(4)
    s_nop 0
    v_pk_fma_f32 v[70:71], v[48:49], v[16:17], v[90:91]
    v_pk_fma_f32 v[72:73], v[50:51], v[16:17], v[92:93]
    v_pk_fma_f32 v[124:125], v[124:125], v[14:15], v[70:71]
    v_pk_fma_f32 v[126:127], v[126:127], v[14:15], v[72:73]
    s_waitcnt lgkmcnt(2)
    s_nop 0
    v_pk_fma_f32 v[74:75], v[52:53], v[16:17], v[94:95]
    v_pk_fma_f32 v[76:77], v[54:55], v[16:17], v[96:97]
    v_pk_fma_f32 v[128:129], v[128:129], v[14:15], v[74:75]
    v_pk_fma_f32 v[130:131], v[130:131], v[14:15], v[76:77]
    s_waitcnt lgkmcnt(0)
    s_nop 0
    v_pk_fma_f32 v[78:79], v[56:57], v[16:17], v[98:99]
    v_pk_fma_f32 v[80:81], v[58:59], v[16:17], v[100:101]
    v_pk_fma_f32 v[132:133], v[132:133], v[14:15], v[78:79]
    v_pk_fma_f32 v[134:135], v[134:135], v[14:15], v[80:81]
    ds_read_b128 v[44:47], v24 offset:0
    ds_read_b128 v[86:89], v24 offset:512
    ds_read_b128 v[48:51], v24 offset:32
    ds_read_b128 v[90:93], v24 offset:544
    ds_read_b128 v[52:55], v24 offset:64
    ds_read_b128 v[94:97], v24 offset:576
    ds_read_b128 v[56:59], v24 offset:96
    ds_read_b128 v[98:101], v24 offset:608
    s_cmp_ge_u32 s13, 0x7ff00000
    s_cbranch_scc1 L_skt1
    s_nop 0
    v_pk_mul_f32 v[66:67], v[120:121], v[120:121]
    v_pk_mul_f32 v[68:69], v[122:123], v[122:123]
    v_pk_mul_f32 v[70:71], v[124:125], v[124:125]
    v_pk_mul_f32 v[72:73], v[126:127], v[126:127]
    v_pk_mul_f32 v[74:75], v[128:129], v[128:129]
    v_pk_mul_f32 v[76:77], v[130:131], v[130:131]
    v_pk_mul_f32 v[78:79], v[132:133], v[132:133]
    v_pk_mul_f32 v[80:81], v[134:135], v[134:135]
    v_pk_fma_f32 v[66:67], v[66:67], s[18:19], v[42:43]
    v_pk_fma_f32 v[68:69], v[68:69], s[18:19], v[42:43]
    v_pk_fma_f32 v[70:71], v[70:71], s[18:19], v[42:43]
    v_pk_fma_f32 v[72:73], v[72:73], s[18:19], v[42:43]
    v_pk_fma_f32 v[74:75], v[74:75], s[18:19], v[42:43]
    v_pk_fma_f32 v[76:77], v[76:77], s[18:19], v[42:43]
    v_pk_fma_f32 v[78:79], v[78:79], s[18:19], v[42:43]
    v_pk_fma_f32 v[80:81], v[80:81], s[18:19], v[42:43]
    v_pk_mul_f32 v[66:67], v[66:67], v[120:121]
    v_pk_mul_f32 v[68:69], v[68:69], v[122:123]
    v_pk_mul_f32 v[70:71], v[70:71], v[124:125]
    v_pk_mul_f32 v[72:73], v[72:73], v[126:127]
    v_pk_mul_f32 v[74:75], v[74:75], v[128:129]
    v_pk_mul_f32 v[76:77], v[76:77], v[130:131]
    v_pk_mul_f32 v[78:79], v[78:79], v[132:133]
    v_pk_mul_f32 v[80:81], v[80:81], v[134:135]
    v_exp_f32 v66, v66
    v_exp_f32 v67, v67
    v_exp_f32 v68, v68
    v_exp_f32 v69, v69
    v_exp_f32 v70, v70
    v_exp_f32 v71, v71
    v_exp_f32 v72, v72
    v_exp_f32 v73, v73
    v_exp_f32 v74, v74
    v_exp_f32 v75, v75
    v_exp_f32 v76, v76
    v_exp_f32 v77, v77
    v_exp_f32 v78, v78
    v_exp_f32 v79, v79
    v_exp_f32 v80, v80
    v_exp_f32 v81, v81
    v_pk_add_f32 v[66:67], v[66:67], 1.0 op_sel_hi:[1,0]
    v_pk_add_f32 v[68:69], v[68:69], 1.0 op_sel_hi:[1,0]
    v_pk_add_f32 v[70:71], v[70:71], 1.0 op_sel_hi:[1,0]
    v_pk_add_f32 v[72:73], v[72:73], 1.0 op_sel_hi:[1,0]
    v_pk_add_f32 v[74:75], v[74:75], 1.0 op_sel_hi:[1,0]
    v_pk_add_f32 v[76:77], v[76:77], 1.0 op_sel_hi:[1,0]
    v_pk_add_f32 v[78:79], v[78:79], 1.0 op_sel_hi:[1,0]
    v_pk_add_f32 v[80:81], v[80:81], 1.0 op_sel_hi:[1,0]
    v_rcp_f32 v66, v66
    v_rcp_f32 v67, v67
    v_rcp_f32 v68, v68
    v_rcp_f32 v69, v69
    v_rcp_f32 v70, v70
    v_rcp_f32 v71, v71
    v_rcp_f32 v72, v72
    v_rcp_f32 v73, v73
    v_rcp_f32 v74, v74
    v_rcp_f32 v75, v75
    v_rcp_f32 v76, v76
    v_rcp_f32 v77, v77
    v_rcp_f32 v78, v78
    v_rcp_f32 v79, v79
    v_rcp_f32 v80, v80
    v_rcp_f32 v81, v81
    v_pk_mul_f32 v[66:67], v[66:67], v[120:121]
    v_pk_mul_f32 v[68:69], v[68:69], v[122:123]
    v_pk_mul_f32 v[70:71], v[70:71], v[124:125]
    v_pk_mul_f32 v[72:73], v[72:73], v[126:127]
    v_pk_mul_f32 v[74:75], v[74:75], v[128:129]
    v_pk_mul_f32 v[76:77], v[76:77], v[130:131]
    v_pk_mul_f32 v[78:79], v[78:79], v[132:133]
    v_pk_mul_f32 v[80:81], v[80:81], v[134:135]
    v_cvt_pk_bf16_f32 v120, v66, v67
    v_cvt_pk_bf16_f32 v121, v68, v69
    v_cvt_pk_bf16_f32 v122, v70, v71
    v_cvt_pk_bf16_f32 v123, v72, v73
    v_cvt_pk_bf16_f32 v124, v74, v75
    v_cvt_pk_bf16_f32 v125, v76, v77
    v_cvt_pk_bf16_f32 v126, v78, v79
    v_cvt_pk_bf16_f32 v127, v80, v81
    buffer_store_dwordx4 v[120:123], v38, s[52:55], s13 offen sc1
    buffer_store_dwordx4 v[124:127], v38, s[52:55], s13 offen offset:512 sc1
L_skt1:
    s_waitcnt lgkmcnt(6)
    s_nop 0
    v_pk_fma_f32 v[66:67], v[44:45], v[16:17], v[86:87]
    v_pk_fma_f32 v[68:69], v[46:47], v[16:17], v[88:89]
    v_pk_fma_f32 v[136:137], v[136:137], v[14:15], v[66:67]
    v_pk_fma_f32 v[138:139], v[138:139], v[14:15], v[68:69]
    s_waitcnt lgkmcnt(4)
    s_nop 0
    v_pk_fma_f32 v[70:71], v[48:49], v[16:17], v[90:91]
    v_pk_fma_f32 v[72:73], v[50:51], v[16:17], v[92:93]
    v_pk_fma_f32 v[140:141], v[140:141], v[14:15], v[70:71]
    v_pk_fma_f32 v[142:143], v[142:143], v[14:15], v[72:73]
    s_waitcnt lgkmcnt(2)
    s_nop 0
    v_pk_fma_f32 v[74:75], v[52:53], v[16:17], v[94:95]
    v_pk_fma_f32 v[76:77], v[54:55], v[16:17], v[96:97]
    v_pk_fma_f32 v[144:145], v[144:145], v[14:15], v[74:75]
    v_pk_fma_f32 v[146:147], v[146:147], v[14:15], v[76:77]
    s_waitcnt lgkmcnt(0)
    s_nop 0
    v_pk_fma_f32 v[78:79], v[56:57], v[16:17], v[98:99]
    v_pk_fma_f32 v[80:81], v[58:59], v[16:17], v[100:101]
    v_pk_fma_f32 v[148:149], v[148:149], v[14:15], v[78:79]
    v_pk_fma_f32 v[150:151], v[150:151], v[14:15], v[80:81]
    ds_read_b128 v[44:47], v25 offset:0
    ds_read_b128 v[86:89], v25 offset:512
    ds_read_b128 v[48:51], v25 offset:32
    ds_read_b128 v[90:93], v25 offset:544
    ds_read_b128 v[52:55], v25 offset:64
    ds_read_b128 v[94:97], v25 offset:576
    ds_read_b128 v[56:59], v25 offset:96
    ds_read_b128 v[98:101], v25 offset:608
    s_cmp_ge_u32 s14, 0x7ff00000
    s_cbranch_scc1 L_skt2
    s_nop 0
    v_pk_mul_f32 v[66:67], v[136:137], v[136:137]
    v_pk_mul_f32 v[68:69], v[138:139], v[138:139]
    v_pk_mul_f32 v[70:71], v[140:141], v[140:141]
    v_pk_mul_f32 v[72:73], v[142:143], v[142:143]
    v_pk_mul_f32 v[74:75], v[144:145], v[144:145]
    v_pk_mul_f32 v[76:77], v[146:147], v[146:147]
    v_pk_mul_f32 v[78:79], v[148:149], v[148:149]
    v_pk_mul_f32 v[80:81], v[150:151], v[150:151]
    v_pk_fma_f32 v[66:67], v[66:67], s[18:19], v[42:43]
    v_pk_fma_f32 v[68:69], v[68:69], s[18:19], v[42:43]
    v_pk_fma_f32 v[70:71], v[70:71], s[18:19], v[42:43]
    v_pk_fma_f32 v[72:73], v[72:73], s[18:19], v[42:43]
    v_pk_fma_f32 v[74:75], v[74:75], s[18:19], v[42:43]
    v_pk_fma_f32 v[76:77], v[76:77], s[18:19], v[42:43]
    v_pk_fma_f32 v[78:79], v[78:79], s[18:19], v[42:43]
    v_pk_fma_f32 v[80:81], v[80:81], s[18:19], v[42:43]
    v_pk_mul_f32 v[66:67], v[66:67], v[136:137]
    v_pk_mul_f32 v[68:69], v[68:69], v[138:139]
    v_pk_mul_f32 v[70:71], v[70:71], v[140:141]
    v_pk_mul_f32 v[72:73], v[72:73], v[142:143]
    v_pk_mul_f32 v[74:75], v[74:75], v[144:145]
    v_pk_mul_f32 v[76:77], v[76:77], v[146:147]
    v_pk_mul_f32 v[78:79], v[78:79], v[148:149]
    v_pk_mul_f32 v[80:81], v[80:81], v[150:151]
    v_exp_f32 v66, v66
    v_exp_f32 v67, v67
    v_exp_f32 v68, v68
    v_exp_f32 v69, v69
    v_exp_f32 v70, v70
    v_exp_f32 v71, v71
    v_exp_f32 v72, v72
    v_exp_f32 v73, v73
    v_exp_f32 v74, v74
    v_exp_f32 v75, v75
    v_exp_f32 v76, v76
    v_exp_f32 v77, v77
    v_exp_f32 v78, v78
    v_exp_f32 v79, v79
    v_exp_f32 v80, v80
    v_exp_f32 v81, v81
    v_pk_add_f32 v[66:67], v[66:67], 1.0 op_sel_hi:[1,0]
    v_pk_add_f32 v[68:69], v[68:69], 1.0 op_sel_hi:[1,0]
    v_pk_add_f32 v[70:71], v[70:71], 1.0 op_sel_hi:[1,0]
    v_pk_add_f32 v[72:73], v[72:73], 1.0 op_sel_hi:[1,0]
    v_pk_add_f32 v[74:75], v[74:75], 1.0 op_sel_hi:[1,0]
    v_pk_add_f32 v[76:77], v[76:77], 1.0 op_sel_hi:[1,0]
    v_pk_add_f32 v[78:79], v[78:79], 1.0 op_sel_hi:[1,0]
    v_pk_add_f32 v[80:81], v[80:81], 1.0 op_sel_hi:[1,0]
    v_rcp_f32 v66, v66
    v_rcp_f32 v67, v67
    v_rcp_f32 v68, v68
    v_rcp_f32 v69, v69
    v_rcp_f32 v70, v70
    v_rcp_f32 v71, v71
    v_rcp_f32 v72, v72
    v_rcp_f32 v73, v73
    v_rcp_f32 v74, v74
    v_rcp_f32 v75, v75
    v_rcp_f32 v76, v76
    v_rcp_f32 v77, v77
    v_rcp_f32 v78, v78
    v_rcp_f32 v79, v79
    v_rcp_f32 v80, v80
    v_rcp_f32 v81, v81
    v_pk_mul_f32 v[66:67], v[66:67], v[136:137]
    v_pk_mul_f32 v[68:69], v[68:69], v[138:139]
    v_pk_mul_f32 v[70:71], v[70:71], v[140:141]
    v_pk_mul_f32 v[72:73], v[72:73], v[142:143]
    v_pk_mul_f32 v[74:75], v[74:75], v[144:145]
    v_pk_mul_f32 v[76:77], v[76:77], v[146:147]
    v_pk_mul_f32 v[78:79], v[78:79], v[148:149]
    v_pk_mul_f32 v[80:81], v[80:81], v[150:151]
    v_cvt_pk_bf16_f32 v136, v66, v67
    v_cvt_pk_bf16_f32 v137, v68, v69
    v_cvt_pk_bf16_f32 v138, v70, v71
    v_cvt_pk_bf16_f32 v139, v72, v73
    v_cvt_pk_bf16_f32 v140, v74, v75
    v_cvt_pk_bf16_f32 v141, v76, v77
    v_cvt_pk_bf16_f32 v142, v78, v79
    v_cvt_pk_bf16_f32 v143, v80, v81
    buffer_store_dwordx4 v[136:139], v38, s[52:55], s14 offen sc1
    buffer_store_dwordx4 v[140:143], v38, s[52:55], s14 offen offset:512 sc1
L_skt2:
    s_waitcnt lgkmcnt(6)
    s_nop 0
    v_pk_fma_f32 v[66:67], v[44:45], v[16:17], v[86:87]
    v_pk_fma_f32 v[68:69], v[46:47], v[16:17], v[88:89]
    v_pk_fma_f32 v[152:153], v[152:153], v[14:15], v[66:67]
    v_pk_fma_f32 v[154:155], v[154:155], v[14:15], v[68:69]
    s_waitcnt lgkmcnt(4)
    s_nop 0
    v_pk_fma_f32 v[70:71], v[48:49], v[16:17], v[90:91]
    v_pk_fma_f32 v[72:73], v[50:51], v[16:17], v[92:93]
    v_pk_fma_f32 v[156:157], v[156:157], v[14:15], v[70:71]
    v_pk_fma_f32 v[158:159], v[158:159], v[14:15], v[72:73]
    s_waitcnt lgkmcnt(2)
    s_nop 0
    v_pk_fma_f32 v[74:75], v[52:53], v[16:17], v[94:95]
    v_pk_fma_f32 v[76:77], v[54:55], v[16:17], v[96:97]
    v_pk_fma_f32 v[160:161], v[160:161], v[14:15], v[74:75]
    v_pk_fma_f32 v[162:163], v[162:163], v[14:15], v[76:77]
    s_waitcnt lgkmcnt(0)
    s_nop 0
    v_pk_fma_f32 v[78:79], v[56:57], v[16:17], v[98:99]
    v_pk_fma_f32 v[80:81], v[58:59], v[16:17], v[100:101]
    v_pk_fma_f32 v[164:165], v[164:165], v[14:15], v[78:79]
    v_pk_fma_f32 v[166:167], v[166:167], v[14:15], v[80:81]
    s_cmp_ge_u32 s15, 0x7ff00000
    s_cbranch_scc1 L_skt3
    s_nop 0
    v_pk_mul_f32 v[66:67], v[152:153], v[152:153]
    v_pk_mul_f32 v[68:69], v[154:155], v[154:155]
    v_pk_mul_f32 v[70:71], v[156:157], v[156:157]
    v_pk_mul_f32 v[72:73], v[158:159], v[158:159]
    v_pk_mul_f32 v[74:75], v[160:161], v[160:161]
    v_pk_mul_f32 v[76:77], v[162:163], v[162:163]
    v_pk_mul_f32 v[78:79], v[164:165], v[164:165]
    v_pk_mul_f32 v[80:81], v[166:167], v[166:167]
    v_pk_fma_f32 v[66:67], v[66:67], s[18:19], v[42:43]
    v_pk_fma_f32 v[68:69], v[68:69], s[18:19], v[42:43]
    v_pk_fma_f32 v[70:71], v[70:71], s[18:19], v[42:43]
    v_pk_fma_f32 v[72:73], v[72:73], s[18:19], v[42:43]
    v_pk_fma_f32 v[74:75], v[74:75], s[18:19], v[42:43]
    v_pk_fma_f32 v[76:77], v[76:77], s[18:19], v[42:43]
    v_pk_fma_f32 v[78:79], v[78:79], s[18:19], v[42:43]
    v_pk_fma_f32 v[80:81], v[80:81], s[18:19], v[42:43]
    v_pk_mul_f32 v[66:67], v[66:67], v[152:153]
    v_pk_mul_f32 v[68:69], v[68:69], v[154:155]
    v_pk_mul_f32 v[70:71], v[70:71], v[156:157]
    v_pk_mul_f32 v[72:73], v[72:73], v[158:159]
    v_pk_mul_f32 v[74:75], v[74:75], v[160:161]
    v_pk_mul_f32 v[76:77], v[76:77], v[162:163]
    v_pk_mul_f32 v[78:79], v[78:79], v[164:165]
    v_pk_mul_f32 v[80:81], v[80:81], v[166:167]
    v_exp_f32 v66, v66
    v_exp_f32 v67, v67
    v_exp_f32 v68, v68
    v_exp_f32 v69, v69
    v_exp_f32 v70, v70
    v_exp_f32 v71, v71
    v_exp_f32 v72, v72
    v_exp_f32 v73, v73
    v_exp_f32 v74, v74
    v_exp_f32 v75, v75
    v_exp_f32 v76, v76
    v_exp_f32 v77, v77
    v_exp_f32 v78, v78
    v_exp_f32 v79, v79
    v_exp_f32 v80, v80
    v_exp_f32 v81, v81
    v_pk_add_f32 v[66:67], v[66:67], 1.0 op_sel_hi:[1,0]
    v_pk_add_f32 v[68:69], v[68:69], 1.0 op_sel_hi:[1,0]
    v_pk_add_f32 v[70:71], v[70:71], 1.0 op_sel_hi:[1,0]
    v_pk_add_f32 v[72:73], v[72:73], 1.0 op_sel_hi:[1,0]
    v_pk_add_f32 v[74:75], v[74:75], 1.0 op_sel_hi:[1,0]
    v_pk_add_f32 v[76:77], v[76:77], 1.0 op_sel_hi:[1,0]
    v_pk_add_f32 v[78:79], v[78:79], 1.0 op_sel_hi:[1,0]
    v_pk_add_f32 v[80:81], v[80:81], 1.0 op_sel_hi:[1,0]
    v_rcp_f32 v66, v66
    v_rcp_f32 v67, v67
    v_rcp_f32 v68, v68
    v_rcp_f32 v69, v69
    v_rcp_f32 v70, v70
    v_rcp_f32 v71, v71
    v_rcp_f32 v72, v72
    v_rcp_f32 v73, v73
    v_rcp_f32 v74, v74
    v_rcp_f32 v75, v75
    v_rcp_f32 v76, v76
    v_rcp_f32 v77, v77
    v_rcp_f32 v78, v78
    v_rcp_f32 v79, v79
    v_rcp_f32 v80, v80
    v_rcp_f32 v81, v81
    v_pk_mul_f32 v[66:67], v[66:67], v[152:153]
    v_pk_mul_f32 v[68:69], v[68:69], v[154:155]
    v_pk_mul_f32 v[70:71], v[70:71], v[156:157]
    v_pk_mul_f32 v[72:73], v[72:73], v[158:159]
    v_pk_mul_f32 v[74:75], v[74:75], v[160:161]
    v_pk_mul_f32 v[76:77], v[76:77], v[162:163]
    v_pk_mul_f32 v[78:79], v[78:79], v[164:165]
    v_pk_mul_f32 v[80:81], v[80:81], v[166:167]
    v_cvt_pk_bf16_f32 v152, v66, v67
    v_cvt_pk_bf16_f32 v153, v68, v69
    v_cvt_pk_bf16_f32 v154, v70, v71
    v_cvt_pk_bf16_f32 v155, v72, v73
    v_cvt_pk_bf16_f32 v156, v74, v75
    v_cvt_pk_bf16_f32 v157, v76, v77
    v_cvt_pk_bf16_f32 v158, v78, v79
    v_cvt_pk_bf16_f32 v159, v80, v81
L_skt3:
    v_mov_b32_e64 v12, 2
    ds_write_b32 v7, v12 offset:176
    buffer_store_dwordx4 v[152:155], v38, s[52:55], s15 offen sc1
    buffer_store_dwordx4 v[156:159], v38, s[52:55], s15 offen offset:512 sc1
    s_setprio 0
    v_lshlrev_b32_e64 v13, 7, v1
    v_cmp_gt_u32 vcc, 8, v1
    v_mov_b32 v3, 0xffffff00
    s_nop 0
    v_cndmask_b32 v13, v3, v13, vcc
    s_branch L_joinA
L_freeA:
    v_mov_b32 v12, 8
    ds_write_b32 v7, v12 offset:176
    ds_write_b32 v7, v12 offset:16
    ds_write_b32 v7, v12 offset:64
    v_mov_b32 v13, 0xffffff00
    s_mov_b32 s100, 0
    s_xor_b32 s3, s65, 1
    s_xor_b32 s4, s2, 176
    s_or_b32 s3, s3, s4
    s_cbranch_scc1 L_noep
    v_lshlrev_b32_e64 v48, 9, v1
    s_mov_b32 s3, 65656
    s_mov_b32 s7, 32768
    s_sleep 64
L_ep:
    s_nop 0
    buffer_load_dword v44, v48, s[52:55], s3 offen sc1
    buffer_load_dword v45, v48, s[52:55], s3 offen offset:128 sc1
    buffer_load_dword v46, v48, s[52:55], s3 offen offset:256 sc1
    buffer_load_dword v47, v48, s[52:55], s3 offen offset:384 sc1
    s_waitcnt vmcnt(0)
    v_xor_b32 v44, s56, v44
    v_xor_b32 v45, s56, v45
    v_xor_b32 v46, s56, v46
    v_xor_b32_e64 v47, s56, v47
    v_or3_b32 v44, v44, v45, v46
    v_or_b32_e64 v44, v44, v47
    v_cmp_ne_u32 vcc, 0, v44
    s_cbranch_vccz L_epok
    s_sleep 32
    s_sub_u32 s7, s7, 1
    s_cbranch_scc0 L_ep
L_epok:
    s_mov_b32 s3, 0
    buffer_store_dword v5, v4, s[52:55], s3 offen sc1
L_noep:
L_joinA:
    s_lshl_b32 s3, s58, 1
    s_lshr_b32 s4, s65, 1
    s_add_u32 s3, s3, s4
    s_lshl_b32 s3, s3, 3
    s_add_u32 s3, s3, s59
    s_lshl_b32 s31, s3, 7
    s_add_u32 s31, s31, 196608
    s_lshl_b32 s3, s58, 2
    s_add_u32 s3, s3, s65
    s_mul_i32 s3, s3, 43
    s_mul_i32 s4, s66, 24
    s_add_u32 s3, s3, s4
    s_add_u32 s3, s3, s68
    s_lshl_b32 s28, s3, 10
    s_add_u32 s28, s28, 5242880
    s_add_u32 s4, s68, s67
    s_lshl_b32 s4, s4, 10
    s_sub_u32 s29, s28, s4
    v_bfe_u32 v58, v1, 2, 3
    v_lshrrev_b32_e64 v59, 5, v1
    v_lshl_add_u32 v59, v59, 4, v58
    v_lshlrev_b32 v59, 7, v59
    v_and_b32 v60, 3, v1
    v_lshl_add_u32 v59, v60, 3, v59
    s_lshl_b32 s3, s66, 12
    v_add_u32 v59, s3, v59
    v_lshrrev_b32 v58, 1, v58
    s_lshl_b32 s3, s66, 1
    v_xor_b32 v58, s3, v58
    v_xor_b32 v14, 0, v58
    v_lshl_add_u32 v14, v14, 5, v59
    v_add_u32 v18, 57344, v14
    v_add_u32 v22, 114688, v14
    v_xor_b32_e64 v15, 1, v58
    v_lshl_add_u32 v15, v15, 5, v59
    v_add_u32 v19, 57344, v15
    v_add_u32 v23, 114688, v15
    v_xor_b32_e64 v16, 2, v58
    v_lshl_add_u32 v16, v16, 5, v59
    v_add_u32 v20, 57344, v16
    v_add_u32 v24, 114688, v16
    v_xor_b32_e64 v17, 3, v58
    v_lshl_add_u32 v17, v17, 5, v59
    v_add_u32 v21, 57344, v17
    v_add_u32 v25, 114688, v17
    v_bfe_u32 v74, v1, 4, 1
    v_lshrrev_b32 v59, 5, v1
    v_lshlrev_b32 v74, 5, v74
    v_lshl_add_u32 v74, v59, 4, v74
    v_and_b32_e64 v59, 15, v1
    v_lshl_add_u32 v50, v59, 10, v74
    v_lshlrev_b32_e64 v61, 4, v59
    s_lshl_b32 s3, s58, 2
    s_add_u32 s3, s3, s65
    s_lshl_b32 s34, s59, 7
    s_lshl_b32 s5, s66, 6
    s_add_u32 s34, s34, s5
    s_lshl_b32 s32, s3, 14
    s_add_u32 s32, s32, s34
    s_lshl_b32 s3, s3, 8
    s_add_u32 s33, s3, 65536
    v_lshlrev_b32_e64 v51, 6, v74
    v_bfe_u32 v60, v1, 2, 2
    v_lshl_add_u32 v51, v60, 7, v51
    v_and_b32_e64 v60, 3, v1
    v_lshl_add_u32 v51, v60, 3, v51
    s_lshl_b32 s3, s66, 12
    s_lshl_b32 s5, s65, 5
    s_add_u32 s3, s3, s5
    s_add_u32 s3, s3, 124800
    v_add_u32_e64 v51, s3, v51
    s_lshl_b32 s3, s62, 11
    s_add_u32 s3, s3, 139264
    v_add_u32_e64 v52, s3, v2
    s_xor_b32 s3, s62, 4
    s_lshl_b32 s3, s3, 11
    s_add_u32 s3, s3, 139264
    v_add_u32 v53, s3, v2
    s_lshl_b32 s3, s66, 4
    v_add_u32 v54, s3, v7
    v_xor_b32 v56, 16, v54
    s_lshl_b32 s3, s66, 2
    v_add_u32 v55, s3, v6
    s_lshr_b32 s3, s65, 1
    s_lshl_b32 s3, s3, 2
    v_add_u32 v57, s3, v6
    s_waitcnt vmcnt(0)
    buffer_store_dword v5, v13, s[52:55], s100 offen sc1
    v_mov_b32 v13, 0xffffff00
    ds_read_b32 v8, v6 offset:240
    s_waitcnt lgkmcnt(0)
    v_cmp_gt_u32 vcc, 3, v8
    s_cbranch_vccnz L_fs_155
L_fr_156:
    s_nop 0
    buffer_load_dwordx4 v[62:65], v50, s[8:11], s32 offen
    buffer_load_dwordx4 v[70:73], v74, s[44:47], s34 offen
    buffer_load_dwordx4 v[66:69], v61, s[52:55], s33 offen sc1
    s_and_b32 s3, s65, 1
    s_cbranch_scc1 L_nop1
    s_mov_b32 s7, 32768
L_sp_158:
    s_load_dwordx16 s[12:27], s[52:53], s31 glc
    s_waitcnt lgkmcnt(0)
    s_mov_b32 s23, s56
    s_xor_b64 s[12:13], s[12:13], s[56:57]
    s_xor_b64 s[14:15], s[14:15], s[56:57]
    s_xor_b64 s[16:17], s[16:17], s[56:57]
    s_xor_b64 s[18:19], s[18:19], s[56:57]
    s_xor_b64 s[20:21], s[20:21], s[56:57]
    s_xor_b64 s[22:23], s[22:23], s[56:57]
    s_or_b64 s[12:13], s[12:13], s[14:15]
    s_or_b64 s[12:13], s[12:13], s[16:17]
    s_or_b64 s[12:13], s[12:13], s[18:19]
    s_or_b64 s[12:13], s[12:13], s[20:21]
    s_or_b64 s[12:13], s[12:13], s[22:23]
    s_cbranch_scc0 L_spok_159
    s_sleep 3
    s_sub_u32 s7, s7, 1
    s_cbranch_scc0 L_sp_158
L_spok_159:
    v_mov_b32 v12, 1
    ds_write_b32 v57, v12 offset:120
L_nop1:
    ds_read_b32 v8, v57 offset:120
    s_waitcnt lgkmcnt(0)
    v_cmp_gt_u32 vcc, 1, v8
    s_cbranch_vccnz L_fs_160
L_fr_161:
    s_cmp_lt_u32 0, s67
    s_cselect_b32 s3, s28, s29
    s_add_u32 s3, s3, 0
    buffer_load_dwordx4 v[136:139], v2, s[52:55], s3 offen sc1
    s_cmp_lt_u32 1, s67
    s_cselect_b32 s3, s28, s29
    s_add_u32 s3, s3, 1024
    buffer_load_dwordx4 v[140:143], v2, s[52:55], s3 offen sc1
    s_cmp_lt_u32 2, s67
    s_cselect_b32 s3, s28, s29
    s_add_u32 s3, s3, 2048
    buffer_load_dwordx4 v[144:147], v2, s[52:55], s3 offen sc1
    s_cmp_lt_u32 3, s67
    s_cselect_b32 s3, s28, s29
    s_add_u32 s3, s3, 3072
    buffer_load_dwordx4 v[148:151], v2, s[52:55], s3 offen sc1
    s_waitcnt vmcnt(4)
    v_cmp_ne_u32 vcc, s56, v68
    s_cbranch_vccnz L_poll_163
L_pok_164:
    v_lshlrev_b32 v76, 16, v66
    v_and_b32 v78, s63, v66
    v_lshlrev_b32 v77, 16, v66
    v_rcp_f32 v78, v78
    v_lshlrev_b32 v26, 16, v62
    v_and_b32 v27, s63, v62
    v_lshlrev_b32 v28, 16, v63
    v_and_b32 v29, s63, v63
    v_lshlrev_b32 v30, 16, v64
    v_and_b32 v31, s63, v64
    v_lshlrev_b32 v32, 16, v65
    v_and_b32 v33, s63, v65
    v_mov_b32 v79, v78
    v_pk_add_f32 v[34:35], v[26:27], v[76:77] neg_lo:[0,1] neg_hi:[0,1]
    v_pk_add_f32 v[36:37], v[28:29], v[76:77] neg_lo:[0,1] neg_hi:[0,1]
    v_pk_add_f32 v[38:39], v[30:31], v[76:77] neg_lo:[0,1] neg_hi:[0,1]
    v_pk_add_f32 v[40:41], v[32:33], v[76:77] neg_lo:[0,1] neg_hi:[0,1]
    v_pk_mul_f32 v[34:35], v[34:35], v[78:79]
    v_pk_mul_f32 v[36:37], v[36:37], v[78:79]
    v_pk_mul_f32 v[38:39], v[38:39], v[78:79]
    v_pk_mul_f32 v[40:41], v[40:41], v[78:79]
    v_lshlrev_b32 v42, 16, v70
    v_and_b32 v43, s63, v70
    v_lshlrev_b32 v44, 16, v71
    v_and_b32 v45, s63, v71
    v_lshlrev_b32 v46, 16, v72
    v_and_b32 v47, s63, v72
    v_lshlrev_b32 v48, 16, v73
    v_and_b32 v49, s63, v73
L_G:
    ds_read_b32 v8, v6 offset:240
    s_waitcnt lgkmcnt(0)
    v_cmp_gt_u32 vcc, 3, v8
    s_cbranch_vccnz L_fs_166
L_fr_167:
    s_nop 0
    ds_read_b64_tr_b16 v[80:81], v16 offset:0
    ds_read_b64_tr_b16 v[82:83], v16 offset:1024
    ds_read_b64_tr_b16 v[84:85], v17 offset:0
    ds_read_b64_tr_b16 v[86:87], v17 offset:1024
    ds_read_b64_tr_b16 v[72:73], v14 offset:0
    ds_read_b64_tr_b16 v[74:75], v14 offset:1024
    ds_read_b64_tr_b16 v[76:77], v15 offset:0
    ds_read_b64_tr_b16 v[78:79], v15 offset:1024
    ds_read_b64_tr_b16 v[96:97], v16 offset:8192
    ds_read_b64_tr_b16 v[98:99], v16 offset:9216
    ds_read_b64_tr_b16 v[100:101], v17 offset:8192
    ds_read_b64_tr_b16 v[102:103], v17 offset:9216
    ds_read_b64_tr_b16 v[88:89], v14 offset:8192
    ds_read_b64_tr_b16 v[90:91], v14 offset:9216
    ds_read_b64_tr_b16 v[92:93], v15 offset:8192
    ds_read_b64_tr_b16 v[94:95], v15 offset:9216
    s_waitcnt vmcnt(3)
    s_waitcnt lgkmcnt(14)
    v_mfma_f32_16x16x32_bf16 v[128:131], v[80:83], v[136:139], 0
    s_cmp_lt_u32 4, s67
    s_cselect_b32 s3, s28, s29
    s_add_u32 s3, s3, 4096
    buffer_load_dwordx4 v[152:155], v2, s[52:55], s3 offen sc1
    ds_read_b64_tr_b16 v[112:113], v20 offset:8192
    ds_read_b64_tr_b16 v[114:115], v20 offset:9216
    s_waitcnt lgkmcnt(14)
    v_mfma_f32_16x16x32_bf16 v[132:135], v[84:87], v[136:139], 0
    ds_read_b64_tr_b16 v[116:117], v21 offset:8192
    ds_read_b64_tr_b16 v[118:119], v21 offset:9216
    s_waitcnt lgkmcnt(14)
    v_mfma_f32_16x16x32_bf16 v[120:123], v[72:75], v[136:139], 0
    ds_read_b64_tr_b16 v[104:105], v18 offset:8192
    ds_read_b64_tr_b16 v[106:107], v18 offset:9216
    s_waitcnt lgkmcnt(14)
    v_mfma_f32_16x16x32_bf16 v[124:127], v[76:79], v[136:139], 0
    ds_read_b64_tr_b16 v[108:109], v19 offset:8192
    ds_read_b64_tr_b16 v[110:111], v19 offset:9216
    s_waitcnt vmcnt(3)
    s_waitcnt lgkmcnt(14)
    v_mfma_f32_16x16x32_bf16 v[128:131], v[96:99], v[140:143], v[128:131]
    s_cmp_lt_u32 5, s67
    s_cselect_b32 s3, s28, s29
    s_nop 0
    s_add_u32 s3, s3, 5120
    buffer_load_dwordx4 v[156:159], v2, s[52:55], s3 offen sc1
    ds_read_b64_tr_b16 v[80:81], v20 offset:16384
    ds_read_b64_tr_b16 v[82:83], v20 offset:17408
    s_waitcnt lgkmcnt(14)
    v_mfma_f32_16x16x32_bf16 v[132:135], v[100:103], v[140:143], v[132:135]
    s_nop 0
    ds_read_b32 v8, v6 offset:244
    ds_read_b64_tr_b16 v[84:85], v21 offset:16384
    ds_read_b64_tr_b16 v[86:87], v21 offset:17408
    s_waitcnt lgkmcnt(15)
    v_mfma_f32_16x16x32_bf16 v[120:123], v[88:91], v[140:143], v[120:123]
    ds_read_b64_tr_b16 v[72:73], v18 offset:16384
    ds_read_b64_tr_b16 v[74:75], v18 offset:17408
    s_waitcnt lgkmcnt(15)
    v_mfma_f32_16x16x32_bf16 v[124:127], v[92:95], v[140:143], v[124:127]
    ds_read_b64_tr_b16 v[76:77], v19 offset:16384
    ds_read_b64_tr_b16 v[78:79], v19 offset:17408
    v_mov_b32_e64 v12, 4
    ds_write_b32 v54, v12 offset:128
    s_waitcnt vmcnt(3)
    s_waitcnt lgkmcnt(15)
    v_mfma_f32_16x16x32_bf16 v[128:131], v[112:115], v[144:147], v[128:131]
    s_waitcnt lgkmcnt(7)
    v_cmp_gt_u32 vcc, 8, v8
    s_cbranch_vccnz L_fs_169
L_fr_170:
    s_cmp_lt_u32 6, s67
    s_cselect_b32 s3, s28, s29
    s_nop 0
    s_add_u32 s3, s3, 6144
    buffer_load_dwordx4 v[160:163], v2, s[52:55], s3 offen sc1
    ds_read_b64_tr_b16 v[96:97], v16 offset:16384
    ds_read_b64_tr_b16 v[98:99], v16 offset:17408
    v_mfma_f32_16x16x32_bf16 v[132:135], v[116:119], v[144:147], v[132:135]
    ds_read_b64_tr_b16 v[100:101], v17 offset:16384
    ds_read_b64_tr_b16 v[102:103], v17 offset:17408
    v_mfma_f32_16x16x32_bf16 v[120:123], v[104:107], v[144:147], v[120:123]
    ds_read_b64_tr_b16 v[88:89], v14 offset:16384
    ds_read_b64_tr_b16 v[90:91], v14 offset:17408
    v_mfma_f32_16x16x32_bf16 v[124:127], v[108:111], v[144:147], v[124:127]
    ds_read_b64_tr_b16 v[92:93], v15 offset:16384
    ds_read_b64_tr_b16 v[94:95], v15 offset:17408
    s_waitcnt vmcnt(3)
    v_mfma_f32_16x16x32_bf16 v[128:131], v[80:83], v[148:151], v[128:131]
    s_cmp_lt_u32 7, s67
    s_cselect_b32 s3, s28, s29
    s_nop 0
    s_add_u32 s3, s3, 7168
    buffer_load_dwordx4 v[164:167], v2, s[52:55], s3 offen sc1
    ds_read_b64_tr_b16 v[112:113], v16 offset:24576
    ds_read_b64_tr_b16 v[114:115], v16 offset:25600
    s_waitcnt lgkmcnt(15)
    v_mfma_f32_16x16x32_bf16 v[132:135], v[84:87], v[148:151], v[132:135]
    ds_read_b64_tr_b16 v[116:117], v17 offset:24576
    ds_read_b64_tr_b16 v[118:119], v17 offset:25600
    s_waitcnt lgkmcnt(15)
    v_mfma_f32_16x16x32_bf16 v[120:123], v[72:75], v[148:151], v[120:123]
    ds_read_b64_tr_b16 v[104:105], v14 offset:24576
    ds_read_b64_tr_b16 v[106:107], v14 offset:25600
    s_waitcnt lgkmcnt(15)
    v_mfma_f32_16x16x32_bf16 v[124:127], v[76:79], v[148:151], v[124:127]
    ds_read_b64_tr_b16 v[108:109], v15 offset:24576
    ds_read_b64_tr_b16 v[110:111], v15 offset:25600
    s_waitcnt vmcnt(3)
    s_waitcnt lgkmcnt(14)
    v_mfma_f32_16x16x32_bf16 v[128:131], v[96:99], v[152:155], v[128:131]
    s_cmp_lt_u32 8, s67
    s_cselect_b32 s3, s28, s29
    s_nop 0
    s_add_u32 s3, s3, 8192
    buffer_load_dwordx4 v[136:139], v2, s[52:55], s3 offen sc1
    ds_read_b64_tr_b16 v[80:81], v20 offset:24576
    ds_read_b64_tr_b16 v[82:83], v20 offset:25600
    s_waitcnt lgkmcnt(14)
    v_mfma_f32_16x16x32_bf16 v[132:135], v[100:103], v[152:155], v[132:135]
    ds_read_b64_tr_b16 v[84:85], v21 offset:24576
    ds_read_b64_tr_b16 v[86:87], v21 offset:25600
    s_waitcnt lgkmcnt(14)
    v_mfma_f32_16x16x32_bf16 v[120:123], v[88:91], v[152:155], v[120:123]
    ds_read_b64_tr_b16 v[72:73], v18 offset:24576
    ds_read_b64_tr_b16 v[74:75], v18 offset:25600
    s_waitcnt lgkmcnt(14)
    v_mfma_f32_16x16x32_bf16 v[124:127], v[92:95], v[152:155], v[124:127]
    ds_read_b64_tr_b16 v[76:77], v19 offset:24576
    ds_read_b64_tr_b16 v[78:79], v19 offset:25600
    s_waitcnt vmcnt(3)
    s_waitcnt lgkmcnt(14)
    v_mfma_f32_16x16x32_bf16 v[128:131], v[112:115], v[156:159], v[128:131]
    s_cmp_lt_u32 9, s67
    s_cselect_b32 s3, s28, s29
    s_nop 0
    s_add_u32 s3, s3, 9216
    buffer_load_dwordx4 v[140:143], v2, s[52:55], s3 offen sc1
    ds_read_b64_tr_b16 v[96:97], v20 offset:32768
    ds_read_b64_tr_b16 v[98:99], v20 offset:33792
    s_waitcnt lgkmcnt(14)
    v_mfma_f32_16x16x32_bf16 v[132:135], v[116:119], v[156:159], v[132:135]
    s_nop 0
    ds_read_b32 v8, v6 offset:240
    ds_read_b64_tr_b16 v[100:101], v21 offset:32768
    ds_read_b64_tr_b16 v[102:103], v21 offset:33792
    s_waitcnt lgkmcnt(15)
    v_mfma_f32_16x16x32_bf16 v[120:123], v[104:107], v[156:159], v[120:123]
    ds_read_b64_tr_b16 v[88:89], v18 offset:32768
    ds_read_b64_tr_b16 v[90:91], v18 offset:33792
    s_waitcnt lgkmcnt(15)
    v_mfma_f32_16x16x32_bf16 v[124:127], v[108:111], v[156:159], v[124:127]
    ds_read_b64_tr_b16 v[92:93], v19 offset:32768
    ds_read_b64_tr_b16 v[94:95], v19 offset:33792
    v_mov_b32_e64 v12, 8
    ds_write_b32 v54, v12 offset:128
    s_waitcnt vmcnt(3)
    s_waitcnt lgkmcnt(15)
    v_mfma_f32_16x16x32_bf16 v[128:131], v[80:83], v[160:163], v[128:131]
    s_waitcnt lgkmcnt(7)
    v_cmp_gt_u32 vcc, 12, v8
    s_cbranch_vccnz L_fs_172
L_fr_173:
    s_cmp_lt_u32 10, s67
    s_cselect_b32 s3, s28, s29
    s_nop 0
    s_add_u32 s3, s3, 10240
    buffer_load_dwordx4 v[144:147], v2, s[52:55], s3 offen sc1
    ds_read_b64_tr_b16 v[112:113], v16 offset:32768
    ds_read_b64_tr_b16 v[114:115], v16 offset:33792
    v_mfma_f32_16x16x32_bf16 v[132:135], v[84:87], v[160:163], v[132:135]
    ds_read_b64_tr_b16 v[116:117], v17 offset:32768
    ds_read_b64_tr_b16 v[118:119], v17 offset:33792
    v_mfma_f32_16x16x32_bf16 v[120:123], v[72:75], v[160:163], v[120:123]
    ds_read_b64_tr_b16 v[104:105], v14 offset:32768
    ds_read_b64_tr_b16 v[106:107], v14 offset:33792
    v_mfma_f32_16x16x32_bf16 v[124:127], v[76:79], v[160:163], v[124:127]
    ds_read_b64_tr_b16 v[108:109], v15 offset:32768
    ds_read_b64_tr_b16 v[110:111], v15 offset:33792
    v_mov_b32_e64 v12, 9
    ds_write_b32 v54, v12 offset:128
    s_waitcnt vmcnt(3)
    v_mfma_f32_16x16x32_bf16 v[128:131], v[96:99], v[164:167], v[128:131]
    s_cmp_lt_u32 11, s67
    s_cselect_b32 s3, s28, s29
    s_nop 0
    s_add_u32 s3, s3, 11264
    buffer_load_dwordx4 v[148:151], v2, s[52:55], s3 offen sc1
    ds_read_b64_tr_b16 v[80:81], v16 offset:40960
    ds_read_b64_tr_b16 v[82:83], v16 offset:41984
    s_waitcnt lgkmcnt(15)
    v_mfma_f32_16x16x32_bf16 v[132:135], v[100:103], v[164:167], v[132:135]
    ds_read_b64_tr_b16 v[84:85], v17 offset:40960
    ds_read_b64_tr_b16 v[86:87], v17 offset:41984
    s_waitcnt lgkmcnt(15)
    v_mfma_f32_16x16x32_bf16 v[120:123], v[88:91], v[164:167], v[120:123]
    ds_read_b64_tr_b16 v[72:73], v14 offset:40960
    ds_read_b64_tr_b16 v[74:75], v14 offset:41984
    s_waitcnt lgkmcnt(15)
    v_mfma_f32_16x16x32_bf16 v[124:127], v[92:95], v[164:167], v[124:127]
    ds_read_b64_tr_b16 v[76:77], v15 offset:40960
    ds_read_b64_tr_b16 v[78:79], v15 offset:41984
    s_waitcnt vmcnt(3)
    s_waitcnt lgkmcnt(15)
    v_mfma_f32_16x16x32_bf16 v[128:131], v[112:115], v[136:139], v[128:131]
    s_cmp_lt_u32 12, s67
    s_cselect_b32 s3, s28, s29
    s_nop 0
    s_add_u32 s3, s3, 12288
    buffer_load_dwordx4 v[152:155], v2, s[52:55], s3 offen sc1
    ds_read_b64_tr_b16 v[96:97], v20 offset:40960
    ds_read_b64_tr_b16 v[98:99], v20 offset:41984
    s_waitcnt lgkmcnt(15)
    v_mfma_f32_16x16x32_bf16 v[132:135], v[116:119], v[136:139], v[132:135]
    ds_read_b64_tr_b16 v[100:101], v21 offset:40960
    ds_read_b64_tr_b16 v[102:103], v21 offset:41984
    s_waitcnt lgkmcnt(15)
    v_mfma_f32_16x16x32_bf16 v[120:123], v[104:107], v[136:139], v[120:123]
    ds_read_b64_tr_b16 v[88:89], v18 offset:40960
    ds_read_b64_tr_b16 v[90:91], v18 offset:41984
    s_waitcnt lgkmcnt(15)
    v_mfma_f32_16x16x32_bf16 v[124:127], v[108:111], v[136:139], v[124:127]
    ds_read_b64_tr_b16 v[92:93], v19 offset:40960
    ds_read_b64_tr_b16 v[94:95], v19 offset:41984
    s_waitcnt vmcnt(3)
    s_waitcnt lgkmcnt(14)
    v_mfma_f32_16x16x32_bf16 v[128:131], v[80:83], v[140:143], v[128:131]
    s_cmp_lt_u32 13, s67
    s_cselect_b32 s3, s28, s29
    s_nop 0
    s_add_u32 s3, s3, 13312
    buffer_load_dwordx4 v[156:159], v2, s[52:55], s3 offen sc1
    ds_read_b64_tr_b16 v[112:113], v20 offset:49152
    ds_read_b64_tr_b16 v[114:115], v20 offset:50176
    s_waitcnt lgkmcnt(14)
    v_mfma_f32_16x16x32_bf16 v[132:135], v[84:87], v[140:143], v[132:135]
    s_nop 0
    ds_read_b32 v8, v6 offset:244
    ds_read_b64_tr_b16 v[116:117], v21 offset:49152
    ds_read_b64_tr_b16 v[118:119], v21 offset:50176
    s_waitcnt lgkmcnt(15)
    v_mfma_f32_16x16x32_bf16 v[120:123], v[72:75], v[140:143], v[120:123]
    ds_read_b64_tr_b16 v[104:105], v18 offset:49152
    ds_read_b64_tr_b16 v[106:107], v18 offset:50176
    s_waitcnt lgkmcnt(15)
    v_mfma_f32_16x16x32_bf16 v[124:127], v[76:79], v[140:143], v[124:127]
    ds_read_b64_tr_b16 v[108:109], v19 offset:49152
    ds_read_b64_tr_b16 v[110:111], v19 offset:50176
    s_waitcnt vmcnt(3)
    s_waitcnt lgkmcnt(15)
    v_mfma_f32_16x16x32_bf16 v[128:131], v[96:99], v[144:147], v[128:131]
    s_waitcnt lgkmcnt(6)
    v_cmp_gt_u32 vcc, 15, v8
    s_cbranch_vccnz L_fs_175
L_fr_176:
    s_cmp_lt_u32 14, s67
    s_cselect_b32 s3, s28, s29
    s_nop 0
    s_add_u32 s3, s3, 14336
    buffer_load_dwordx4 v[160:163], v2, s[52:55], s3 offen sc1
    ds_read_b64_tr_b16 v[80:81], v16 offset:49152
    ds_read_b64_tr_b16 v[82:83], v16 offset:50176
    v_mfma_f32_16x16x32_bf16 v[132:135], v[100:103], v[144:147], v[132:135]
    ds_read_b64_tr_b16 v[84:85], v17 offset:49152
    ds_read_b64_tr_b16 v[86:87], v17 offset:50176
    v_mfma_f32_16x16x32_bf16 v[120:123], v[88:91], v[144:147], v[120:123]
    ds_read_b64_tr_b16 v[72:73], v14 offset:49152
    ds_read_b64_tr_b16 v[74:75], v14 offset:50176
    v_mfma_f32_16x16x32_bf16 v[124:127], v[92:95], v[144:147], v[124:127]
    ds_read_b64_tr_b16 v[76:77], v15 offset:49152
    ds_read_b64_tr_b16 v[78:79], v15 offset:50176
    s_waitcnt vmcnt(3)
    v_mfma_f32_16x16x32_bf16 v[128:131], v[112:115], v[148:151], v[128:131]
    s_cmp_lt_u32 15, s67
    s_cselect_b32 s3, s28, s29
    s_nop 0
    s_add_u32 s3, s3, 15360
    buffer_load_dwordx4 v[164:167], v2, s[52:55], s3 offen sc1
    ds_read_b64_tr_b16 v[96:97], v20 offset:0
    ds_read_b64_tr_b16 v[98:99], v20 offset:1024
    s_waitcnt lgkmcnt(14)
    v_mfma_f32_16x16x32_bf16 v[132:135], v[116:119], v[148:151], v[132:135]
    ds_read_b64_tr_b16 v[100:101], v21 offset:0
    ds_read_b64_tr_b16 v[102:103], v21 offset:1024
    s_waitcnt lgkmcnt(14)
    v_mfma_f32_16x16x32_bf16 v[120:123], v[104:107], v[148:151], v[120:123]
    ds_read_b64_tr_b16 v[88:89], v18 offset:0
    ds_read_b64_tr_b16 v[90:91], v18 offset:1024
    s_waitcnt lgkmcnt(14)
    v_mfma_f32_16x16x32_bf16 v[124:127], v[108:111], v[148:151], v[124:127]
    ds_read_b64_tr_b16 v[92:93], v19 offset:0
    ds_read_b64_tr_b16 v[94:95], v19 offset:1024
    s_waitcnt vmcnt(3)
    s_waitcnt lgkmcnt(14)
    v_mfma_f32_16x16x32_bf16 v[128:131], v[80:83], v[152:155], v[128:131]
    s_cmp_lt_u32 16, s67
    s_cselect_b32 s3, s28, s29
    s_nop 0
    s_add_u32 s3, s3, 16384
    buffer_load_dwordx4 v[136:139], v2, s[52:55], s3 offen sc1
    ds_read_b64_tr_b16 v[112:113], v24 offset:0
    ds_read_b64_tr_b16 v[114:115], v24 offset:1024
    s_waitcnt lgkmcnt(14)
    v_mfma_f32_16x16x32_bf16 v[132:135], v[84:87], v[152:155], v[132:135]
    s_nop 0
    ds_read_b32 v8, v55 offset:240
    ds_read_b64_tr_b16 v[116:117], v25 offset:0
    ds_read_b64_tr_b16 v[118:119], v25 offset:1024
    s_waitcnt lgkmcnt(15)
    v_mfma_f32_16x16x32_bf16 v[120:123], v[72:75], v[152:155], v[120:123]
    ds_read_b64_tr_b16 v[104:105], v22 offset:0
    ds_read_b64_tr_b16 v[106:107], v22 offset:1024
    s_waitcnt lgkmcnt(15)
    v_mfma_f32_16x16x32_bf16 v[124:127], v[76:79], v[152:155], v[124:127]
    ds_read_b64_tr_b16 v[108:109], v23 offset:0
    ds_read_b64_tr_b16 v[110:111], v23 offset:1024
    s_waitcnt vmcnt(3)
    s_waitcnt lgkmcnt(15)
    v_mfma_f32_16x16x32_bf16 v[128:131], v[96:99], v[156:159], v[128:131]
    s_waitcnt lgkmcnt(6)
    v_cmp_gt_u32 vcc, 19, v8
    s_cbranch_vccnz L_fs_178
L_fr_179:
    s_cmp_lt_u32 17, s67
    s_cselect_b32 s3, s28, s29
    s_nop 0
    s_add_u32 s3, s3, 17408
    buffer_load_dwordx4 v[140:143], v2, s[52:55], s3 offen sc1
    ds_read_b64_tr_b16 v[80:81], v16 offset:0
    ds_read_b64_tr_b16 v[82:83], v16 offset:1024
    v_mfma_f32_16x16x32_bf16 v[132:135], v[100:103], v[156:159], v[132:135]
    ds_read_b64_tr_b16 v[84:85], v17 offset:0
    ds_read_b64_tr_b16 v[86:87], v17 offset:1024
    v_mfma_f32_16x16x32_bf16 v[120:123], v[88:91], v[156:159], v[120:123]
    ds_read_b64_tr_b16 v[72:73], v14 offset:0
    ds_read_b64_tr_b16 v[74:75], v14 offset:1024
    v_mfma_f32_16x16x32_bf16 v[124:127], v[92:95], v[156:159], v[124:127]
    ds_read_b64_tr_b16 v[76:77], v15 offset:0
    ds_read_b64_tr_b16 v[78:79], v15 offset:1024
    s_waitcnt vmcnt(3)
    v_mfma_f32_16x16x32_bf16 v[128:131], v[112:115], v[160:163], v[128:131]
    s_cmp_lt_u32 18, s67
    s_cselect_b32 s3, s28, s29
    s_nop 0
    s_add_u32 s3, s3, 18432
    buffer_load_dwordx4 v[144:147], v2, s[52:55], s3 offen sc1
    ds_read_b64_tr_b16 v[96:97], v16 offset:8192
    ds_read_b64_tr_b16 v[98:99], v16 offset:9216
    s_waitcnt lgkmcnt(14)
    v_mfma_f32_16x16x32_bf16 v[132:135], v[116:119], v[160:163], v[132:135]
    ds_read_b64_tr_b16 v[100:101], v17 offset:8192
    ds_read_b64_tr_b16 v[102:103], v17 offset:9216
    s_waitcnt lgkmcnt(14)
    v_mfma_f32_16x16x32_bf16 v[120:123], v[104:107], v[160:163], v[120:123]
    ds_read_b64_tr_b16 v[88:89], v14 offset:8192
    ds_read_b64_tr_b16 v[90:91], v14 offset:9216
    s_waitcnt lgkmcnt(14)
    v_mfma_f32_16x16x32_bf16 v[124:127], v[108:111], v[160:163], v[124:127]
    ds_read_b64_tr_b16 v[92:93], v15 offset:8192
    ds_read_b64_tr_b16 v[94:95], v15 offset:9216
    s_cmp_lg_u32 s66, 0
    s_cbranch_scc1 L_g2B
    s_waitcnt vmcnt(3)
    s_waitcnt lgkmcnt(14)
    v_mfma_f32_16x16x32_bf16 v[128:131], v[80:83], v[164:167], v[128:131]
    s_cmp_lt_u32 19, s67
    s_cselect_b32 s3, s28, s29
    s_nop 0
    s_add_u32 s3, s3, 19456
    buffer_load_dwordx4 v[148:151], v2, s[52:55], s3 offen sc1
    ds_read_b64_tr_b16 v[112:113], v20 offset:8192
    ds_read_b64_tr_b16 v[114:115], v20 offset:9216
    s_waitcnt lgkmcnt(14)
    v_mfma_f32_16x16x32_bf16 v[132:135], v[84:87], v[164:167], v[132:135]
    ds_read_b64_tr_b16 v[116:117], v21 offset:8192
    ds_read_b64_tr_b16 v[118:119], v21 offset:9216
    s_waitcnt lgkmcnt(14)
    v_mfma_f32_16x16x32_bf16 v[120:123], v[72:75], v[164:167], v[120:123]
    ds_read_b64_tr_b16 v[104:105], v18 offset:8192
    ds_read_b64_tr_b16 v[106:107], v18 offset:9216
    s_waitcnt lgkmcnt(14)
    v_mfma_f32_16x16x32_bf16 v[124:127], v[76:79], v[164:167], v[124:127]
    ds_read_b64_tr_b16 v[108:109], v19 offset:8192
    ds_read_b64_tr_b16 v[110:111], v19 offset:9216
    s_waitcnt vmcnt(3)
    s_waitcnt lgkmcnt(14)
    v_mfma_f32_16x16x32_bf16 v[128:131], v[96:99], v[136:139], v[128:131]
    s_cmp_lt_u32 20, s67
    s_cselect_b32 s3, s28, s29
    s_nop 0
    s_add_u32 s3, s3, 20480
    buffer_load_dwordx4 v[152:155], v2, s[52:55], s3 offen sc1
    ds_read_b64_tr_b16 v[80:81], v20 offset:16384
    ds_read_b64_tr_b16 v[82:83], v20 offset:17408
    s_waitcnt lgkmcnt(14)
    v_mfma_f32_16x16x32_bf16 v[132:135], v[100:103], v[136:139], v[132:135]
    s_nop 0
    ds_read_b32 v8, v55 offset:240
    ds_read_b64_tr_b16 v[84:85], v21 offset:16384
    ds_read_b64_tr_b16 v[86:87], v21 offset:17408
    s_waitcnt lgkmcnt(15)
    v_mfma_f32_16x16x32_bf16 v[120:123], v[88:91], v[136:139], v[120:123]
    ds_read_b64_tr_b16 v[72:73], v18 offset:16384
    ds_read_b64_tr_b16 v[74:75], v18 offset:17408
    s_waitcnt lgkmcnt(15)
    v_mfma_f32_16x16x32_bf16 v[124:127], v[92:95], v[136:139], v[124:127]
    ds_read_b64_tr_b16 v[76:77], v19 offset:16384
    ds_read_b64_tr_b16 v[78:79], v19 offset:17408
    s_waitcnt vmcnt(3)
    s_waitcnt lgkmcnt(15)
    v_mfma_f32_16x16x32_bf16 v[128:131], v[112:115], v[140:143], v[128:131]
    s_waitcnt lgkmcnt(6)
    v_cmp_gt_u32 vcc, 24, v8
    s_cbranch_vccnz L_fs_181
L_fr_182:
    s_cmp_lt_u32 21, s67
    s_cselect_b32 s3, s28, s29
    s_nop 0
    s_add_u32 s3, s3, 21504
    buffer_load_dwordx4 v[156:159], v2, s[52:55], s3 offen sc1
    ds_read_b64_tr_b16 v[96:97], v16 offset:16384
    ds_read_b64_tr_b16 v[98:99], v16 offset:17408
    v_mfma_f32_16x16x32_bf16 v[132:135], v[116:119], v[140:143], v[132:135]
    ds_read_b64_tr_b16 v[100:101], v17 offset:16384
    ds_read_b64_tr_b16 v[102:103], v17 offset:17408
    v_mfma_f32_16x16x32_bf16 v[120:123], v[104:107], v[140:143], v[120:123]
    ds_read_b64_tr_b16 v[88:89], v14 offset:16384
    ds_read_b64_tr_b16 v[90:91], v14 offset:17408
    v_mfma_f32_16x16x32_bf16 v[124:127], v[108:111], v[140:143], v[124:127]
    ds_read_b64_tr_b16 v[92:93], v15 offset:16384
    ds_read_b64_tr_b16 v[94:95], v15 offset:17408
    s_waitcnt vmcnt(3)
    v_mfma_f32_16x16x32_bf16 v[128:131], v[80:83], v[144:147], v[128:131]
    s_cmp_lt_u32 22, s67
    s_cselect_b32 s3, s28, s29
    s_nop 0
    s_add_u32 s3, s3, 22528
    buffer_load_dwordx4 v[160:163], v2, s[52:55], s3 offen sc1
    ds_read_b64_tr_b16 v[112:113], v16 offset:24576
    ds_read_b64_tr_b16 v[114:115], v16 offset:25600
    s_waitcnt lgkmcnt(14)
    v_mfma_f32_16x16x32_bf16 v[132:135], v[84:87], v[144:147], v[132:135]
    ds_read_b64_tr_b16 v[116:117], v17 offset:24576
    ds_read_b64_tr_b16 v[118:119], v17 offset:25600
    s_waitcnt lgkmcnt(14)
    v_mfma_f32_16x16x32_bf16 v[120:123], v[72:75], v[144:147], v[120:123]
    ds_read_b64_tr_b16 v[104:105], v14 offset:24576
    ds_read_b64_tr_b16 v[106:107], v14 offset:25600
    s_waitcnt lgkmcnt(14)
    v_mfma_f32_16x16x32_bf16 v[124:127], v[76:79], v[144:147], v[124:127]
    ds_read_b64_tr_b16 v[108:109], v15 offset:24576
    ds_read_b64_tr_b16 v[110:111], v15 offset:25600
    s_waitcnt vmcnt(3)
    s_waitcnt lgkmcnt(14)
    v_mfma_f32_16x16x32_bf16 v[128:131], v[96:99], v[148:151], v[128:131]
    s_cmp_lt_u32 23, s67
    s_cselect_b32 s3, s28, s29
    s_nop 0
    s_add_u32 s3, s3, 23552
    buffer_load_dwordx4 v[164:167], v2, s[52:55], s3 offen sc1
    ds_read_b64_tr_b16 v[80:81], v20 offset:24576
    ds_read_b64_tr_b16 v[82:83], v20 offset:25600
    s_waitcnt lgkmcnt(14)
    v_mfma_f32_16x16x32_bf16 v[132:135], v[100:103], v[148:151], v[132:135]
    ds_read_b64_tr_b16 v[84:85], v21 offset:24576
    ds_read_b64_tr_b16 v[86:87], v21 offset:25600
    s_waitcnt lgkmcnt(14)
    v_mfma_f32_16x16x32_bf16 v[120:123], v[88:91], v[148:151], v[120:123]
    ds_read_b64_tr_b16 v[72:73], v18 offset:24576
    ds_read_b64_tr_b16 v[74:75], v18 offset:25600
    s_waitcnt lgkmcnt(14)
    v_mfma_f32_16x16x32_bf16 v[124:127], v[92:95], v[148:151], v[124:127]
    ds_read_b64_tr_b16 v[76:77], v19 offset:24576
    ds_read_b64_tr_b16 v[78:79], v19 offset:25600
    s_waitcnt vmcnt(3)
    s_waitcnt lgkmcnt(14)
    v_mfma_f32_16x16x32_bf16 v[128:131], v[112:115], v[152:155], v[128:131]
    ds_read_b64_tr_b16 v[96:97], v20 offset:32768
    ds_read_b64_tr_b16 v[98:99], v20 offset:33792
    s_waitcnt lgkmcnt(14)
    v_mfma_f32_16x16x32_bf16 v[132:135], v[116:119], v[152:155], v[132:135]
    ds_read_b64_tr_b16 v[100:101], v21 offset:32768
    ds_read_b64_tr_b16 v[102:103], v21 offset:33792
    s_waitcnt lgkmcnt(14)
    v_mfma_f32_16x16x32_bf16 v[120:123], v[104:107], v[152:155], v[120:123]
    ds_read_b64_tr_b16 v[88:89], v18 offset:32768
    ds_read_b64_tr_b16 v[90:91], v18 offset:33792
    s_waitcnt lgkmcnt(14)
    v_mfma_f32_16x16x32_bf16 v[124:127], v[108:111], v[152:155], v[124:127]
    ds_read_b64_tr_b16 v[92:93], v19 offset:32768
    ds_read_b64_tr_b16 v[94:95], v19 offset:33792
    s_waitcnt vmcnt(2)
    s_waitcnt lgkmcnt(14)
    v_mfma_f32_16x16x32_bf16 v[128:131], v[80:83], v[156:159], v[128:131]
    ds_read_b64_tr_b16 v[112:113], v16 offset:32768
    ds_read_b64_tr_b16 v[114:115], v16 offset:33792
    s_waitcnt lgkmcnt(14)
    v_mfma_f32_16x16x32_bf16 v[132:135], v[84:87], v[156:159], v[132:135]
    ds_read_b64_tr_b16 v[116:117], v17 offset:32768
    ds_read_b64_tr_b16 v[118:119], v17 offset:33792
    s_waitcnt lgkmcnt(14)
    v_mfma_f32_16x16x32_bf16 v[120:123], v[72:75], v[156:159], v[120:123]
    ds_read_b64_tr_b16 v[104:105], v14 offset:32768
    ds_read_b64_tr_b16 v[106:107], v14 offset:33792
    s_waitcnt lgkmcnt(14)
    v_mfma_f32_16x16x32_bf16 v[124:127], v[76:79], v[156:159], v[124:127]
    ds_read_b64_tr_b16 v[108:109], v15 offset:32768
    ds_read_b64_tr_b16 v[110:111], v15 offset:33792
    s_waitcnt vmcnt(1)
    s_waitcnt lgkmcnt(14)
    v_mfma_f32_16x16x32_bf16 v[128:131], v[96:99], v[160:163], v[128:131]
    s_waitcnt lgkmcnt(12)
    v_mfma_f32_16x16x32_bf16 v[132:135], v[100:103], v[160:163], v[132:135]
    s_waitcnt lgkmcnt(10)
    v_mfma_f32_16x16x32_bf16 v[120:123], v[88:91], v[160:163], v[120:123]
    s_waitcnt lgkmcnt(8)
    v_mfma_f32_16x16x32_bf16 v[124:127], v[92:95], v[160:163], v[124:127]
    s_waitcnt vmcnt(0)
    s_waitcnt lgkmcnt(6)
    v_mfma_f32_16x16x32_bf16 v[128:131], v[112:115], v[164:167], v[128:131]
    s_waitcnt lgkmcnt(4)
    v_mfma_f32_16x16x32_bf16 v[132:135], v[116:119], v[164:167], v[132:135]
    ds_read_b32 v8, v6 offset:116
    s_waitcnt lgkmcnt(3)
    v_mfma_f32_16x16x32_bf16 v[120:123], v[104:107], v[164:167], v[120:123]
    s_waitcnt lgkmcnt(1)
    v_mfma_f32_16x16x32_bf16 v[124:127], v[108:111], v[164:167], v[124:127]
    s_branch L_g2E
L_g2B:
    s_waitcnt vmcnt(3)
    s_waitcnt lgkmcnt(14)
    v_mfma_f32_16x16x32_bf16 v[128:131], v[80:83], v[164:167], v[128:131]
    ds_read_b64_tr_b16 v[112:113], v20 offset:8192
    ds_read_b64_tr_b16 v[114:115], v20 offset:9216
    s_waitcnt lgkmcnt(14)
    v_mfma_f32_16x16x32_bf16 v[132:135], v[84:87], v[164:167], v[132:135]
    ds_read_b64_tr_b16 v[116:117], v21 offset:8192
    ds_read_b64_tr_b16 v[118:119], v21 offset:9216
    s_waitcnt lgkmcnt(14)
    v_mfma_f32_16x16x32_bf16 v[120:123], v[72:75], v[164:167], v[120:123]
    ds_read_b64_tr_b16 v[104:105], v18 offset:8192
    ds_read_b64_tr_b16 v[106:107], v18 offset:9216
    s_waitcnt lgkmcnt(14)
    v_mfma_f32_16x16x32_bf16 v[124:127], v[76:79], v[164:167], v[124:127]
    ds_read_b64_tr_b16 v[108:109], v19 offset:8192
    ds_read_b64_tr_b16 v[110:111], v19 offset:9216
    s_waitcnt vmcnt(2)
    s_waitcnt lgkmcnt(14)
    v_mfma_f32_16x16x32_bf16 v[128:131], v[96:99], v[136:139], v[128:131]
    ds_read_b64_tr_b16 v[80:81], v20 offset:16384
    ds_read_b64_tr_b16 v[82:83], v20 offset:17408
    s_waitcnt lgkmcnt(14)
    v_mfma_f32_16x16x32_bf16 v[132:135], v[100:103], v[136:139], v[132:135]
    ds_read_b64_tr_b16 v[84:85], v21 offset:16384
    ds_read_b64_tr_b16 v[86:87], v21 offset:17408
    s_waitcnt lgkmcnt(14)
    v_mfma_f32_16x16x32_bf16 v[120:123], v[88:91], v[136:139], v[120:123]
    ds_read_b64_tr_b16 v[72:73], v18 offset:16384
    ds_read_b64_tr_b16 v[74:75], v18 offset:17408
    s_waitcnt lgkmcnt(14)
    v_mfma_f32_16x16x32_bf16 v[124:127], v[92:95], v[136:139], v[124:127]
    ds_read_b64_tr_b16 v[76:77], v19 offset:16384
    ds_read_b64_tr_b16 v[78:79], v19 offset:17408
    s_waitcnt vmcnt(1)
    s_waitcnt lgkmcnt(14)
    v_mfma_f32_16x16x32_bf16 v[128:131], v[112:115], v[140:143], v[128:131]
    s_waitcnt lgkmcnt(12)
    v_mfma_f32_16x16x32_bf16 v[132:135], v[116:119], v[140:143], v[132:135]
    s_waitcnt lgkmcnt(10)
    v_mfma_f32_16x16x32_bf16 v[120:123], v[104:107], v[140:143], v[120:123]
    s_waitcnt lgkmcnt(8)
    v_mfma_f32_16x16x32_bf16 v[124:127], v[108:111], v[140:143], v[124:127]
    s_waitcnt vmcnt(0)
    s_waitcnt lgkmcnt(6)
    v_mfma_f32_16x16x32_bf16 v[128:131], v[80:83], v[144:147], v[128:131]
    s_waitcnt lgkmcnt(4)
    v_mfma_f32_16x16x32_bf16 v[132:135], v[84:87], v[144:147], v[132:135]
    ds_read_b32 v8, v6 offset:116
    s_waitcnt lgkmcnt(3)
    v_mfma_f32_16x16x32_bf16 v[120:123], v[72:75], v[144:147], v[120:123]
    s_waitcnt lgkmcnt(1)
    v_mfma_f32_16x16x32_bf16 v[124:127], v[76:79], v[144:147], v[124:127]
L_g2E:
    s_waitcnt lgkmcnt(0)
    v_cmp_gt_u32 vcc, 1, v8
    s_cbranch_vccnz L_fs_184
L_fr_185:
    ds_read_b64_tr_b16 v[60:61], v51
    ds_read_b64_tr_b16 v[62:63], v51 offset:512
    v_mov_b32 v12, 30
    ds_write_b128 v52, v[128:131]
    ds_write_b128 v52, v[132:135] offset:1024
    ds_write_b32 v54, v12 offset:128
    ds_read_b32 v8, v56 offset:128
    s_mov_b32 s36, 0xbfb8aa3b
    s_mov_b32 s37, s36
    s_waitcnt lgkmcnt(4)
    v_lshlrev_b32 v64, 16, v60
    v_and_b32 v65, s63, v60
    v_pk_mul_f32 v[34:35], v[34:35], v[64:65]
    v_lshlrev_b32 v64, 16, v61
    v_and_b32 v65, s63, v61
    v_pk_mul_f32 v[36:37], v[36:37], v[64:65]
    s_waitcnt lgkmcnt(0)
    v_cmp_gt_u32 vcc, 30, v8
    s_cbranch_vccnz L_fs_187
L_fr_188:
    ds_read_b128 v[66:69], v53
    ds_read_b128 v[70:73], v53 offset:1024
    v_lshlrev_b32 v64, 16, v62
    v_and_b32_e64 v65, s63, v62
    v_pk_mul_f32 v[38:39], v[38:39], v[64:65]
    v_lshlrev_b32 v64, 16, v63
    v_and_b32 v65, s63, v63
    v_pk_mul_f32 v[40:41], v[40:41], v[64:65]
    s_waitcnt lgkmcnt(0)
    s_nop 0
    v_pk_add_f32 v[120:121], v[120:121], v[66:67]
    v_pk_add_f32 v[122:123], v[122:123], v[68:69]
    v_pk_add_f32 v[124:125], v[124:125], v[70:71]
    v_pk_add_f32 v[126:127], v[126:127], v[72:73]
    s_nop 0
    v_permlane16_swap_b32 v120, v124
    v_permlane16_swap_b32 v121, v125
    v_permlane16_swap_b32 v122, v126
    v_permlane16_swap_b32 v123, v127
    s_nop 0
    v_pk_add_f32 v[120:121], v[120:121], v[42:43]
    v_pk_add_f32 v[122:123], v[122:123], v[44:45]
    v_pk_add_f32 v[124:125], v[124:125], v[46:47]
    v_pk_add_f32 v[126:127], v[126:127], v[48:49]
    v_pk_mul_f32 v[66:67], v[120:121], s[36:37]
    v_pk_mul_f32 v[68:69], v[122:123], s[36:37]
    v_pk_mul_f32 v[70:71], v[124:125], s[36:37]
    v_pk_mul_f32 v[72:73], v[126:127], s[36:37]
    v_exp_f32 v66, v66
    v_exp_f32 v67, v67
    v_exp_f32 v68, v68
    v_exp_f32 v69, v69
    v_exp_f32 v70, v70
    v_exp_f32 v71, v71
    v_exp_f32 v72, v72
    v_exp_f32 v73, v73
    v_pk_mul_f32 v[120:121], v[120:121], v[34:35]
    v_pk_mul_f32 v[122:123], v[122:123], v[36:37]
    v_pk_mul_f32 v[124:125], v[124:125], v[38:39]
    v_pk_mul_f32 v[126:127], v[126:127], v[40:41]
    v_pk_add_f32 v[66:67], v[66:67], 1.0 op_sel_hi:[1,0]
    v_pk_add_f32 v[68:69], v[68:69], 1.0 op_sel_hi:[1,0]
    v_pk_add_f32 v[70:71], v[70:71], 1.0 op_sel_hi:[1,0]
    v_pk_add_f32 v[72:73], v[72:73], 1.0 op_sel_hi:[1,0]
    v_rcp_f32 v66, v66
    v_rcp_f32 v67, v67
    v_rcp_f32 v68, v68
    v_rcp_f32 v69, v69
    v_rcp_f32 v70, v70
    v_rcp_f32 v71, v71
    v_rcp_f32 v72, v72
    v_rcp_f32 v73, v73
    v_pk_fma_f32 v[120:121], v[120:121], v[66:67], v[26:27]
    v_pk_fma_f32 v[122:123], v[122:123], v[68:69], v[28:29]
    v_pk_fma_f32 v[124:125], v[124:125], v[70:71], v[30:31]
    v_pk_fma_f32 v[126:127], v[126:127], v[72:73], v[32:33]
    v_cvt_pk_bf16_f32 v66, v120, v121
    v_cvt_pk_bf16_f32 v67, v122, v123
    v_cvt_pk_bf16_f32 v68, v124, v125
    v_cvt_pk_bf16_f32 v69, v126, v127
    buffer_store_dwordx4 v[66:69], v50, s[48:51], s32 offen
L_fin:
L_end:
    s_endpgm
L_fs_122:
L_fl_124:
    s_sleep 1
    ds_read_b32 v8, v6 offset:0
    s_waitcnt lgkmcnt(0)
    v_cmp_gt_u32 vcc, 1, v8
    s_cbranch_vccnz L_fl_124
    s_branch L_fr_123
L_fs_125:
L_fl_127:
    s_sleep 1
    ds_read_b32 v8, v6 offset:4
    s_waitcnt lgkmcnt(0)
    v_cmp_gt_u32 vcc, 2, v8
    s_cbranch_vccnz L_fl_127
    s_branch L_fr_126
L_fs_128:
L_fl_130:
    s_sleep 1
    ds_read_b32 v8, v6 offset:0
    s_waitcnt lgkmcnt(0)
    v_cmp_gt_u32 vcc, 3, v8
    s_cbranch_vccnz L_fl_130
    s_branch L_fr_129
L_fs_131:
L_fl_133:
    s_sleep 1
    ds_read_b32 v8, v6 offset:4
    s_waitcnt lgkmcnt(0)
    v_cmp_gt_u32 vcc, 4, v8
    s_cbranch_vccnz L_fl_133
    s_branch L_fr_132
L_fs_134:
L_fl_136:
    s_sleep 1
    ds_read_b32 v8, v6 offset:0
    s_waitcnt lgkmcnt(0)
    v_cmp_gt_u32 vcc, 5, v8
    s_cbranch_vccnz L_fl_136
    s_branch L_fr_135
L_fs_137:
L_fl_139:
    s_sleep 1
    ds_read_b32 v8, v6 offset:4
    s_waitcnt lgkmcnt(0)
    v_cmp_gt_u32 vcc, 6, v8
    s_cbranch_vccnz L_fl_139
    s_branch L_fr_138
L_fs_140:
L_fl_142:
    s_sleep 1
    ds_read_b32 v8, v6 offset:0
    s_waitcnt lgkmcnt(0)
    v_cmp_gt_u32 vcc, 7, v8
    s_cbranch_vccnz L_fl_142
    s_branch L_fr_141
L_fs_143:
L_fl_145:
    s_sleep 1
    ds_read_b32 v8, v6 offset:4
    s_waitcnt lgkmcnt(0)
    v_cmp_gt_u32 vcc, 8, v8
    s_cbranch_vccnz L_fl_145
    s_branch L_fr_144
L_fs_146:
L_fl_148:
    s_sleep 1
    ds_read_b32 v8, v6 offset:112
    s_waitcnt lgkmcnt(0)
    v_cmp_gt_u32 vcc, 1, v8
    s_cbranch_vccnz L_fl_148
    s_branch L_fr_147
L_poll_149:
    s_mov_b32 s7, 32768
L_pl_151:
    s_sleep 2
    buffer_load_dwordx4 v[34:37], v39, s[52:55], s16 offen sc1
    s_waitcnt vmcnt(0)
    v_cmp_ne_u32 vcc, s56, v36
    s_cbranch_vccz L_pok_150
    s_sub_u32 s7, s7, 1
    s_cbranch_scc0 L_pl_151
    s_branch L_pok_150
L_fs_152:
L_fl_154:
    s_sleep 1
    ds_read_b128 v[8:11], v6 offset:64
    s_waitcnt lgkmcnt(0)
    v_min3_u32 v8, v8, v9, v10
    v_min_u32 v8, v8, v11
    v_cmp_gt_u32 vcc, 1, v8
    s_cbranch_vccnz L_fl_154
    s_branch L_fr_153
L_fs_155:
L_fl_157:
    s_sleep 1
    ds_read_b32 v8, v6 offset:240
    s_waitcnt lgkmcnt(0)
    v_cmp_gt_u32 vcc, 3, v8
    s_cbranch_vccnz L_fl_157
    s_branch L_fr_156
L_fs_160:
L_fl_162:
    s_sleep 1
    ds_read_b32 v8, v57 offset:120
    s_waitcnt lgkmcnt(0)
    v_cmp_gt_u32 vcc, 1, v8
    s_cbranch_vccnz L_fl_162
    s_branch L_fr_161
L_poll_163:
    s_mov_b32 s7, 32768
L_pl_165:
    s_sleep 2
    buffer_load_dwordx4 v[66:69], v61, s[52:55], s33 offen sc1
    s_waitcnt vmcnt(0)
    v_cmp_ne_u32 vcc, s56, v68
    s_cbranch_vccz L_pok_164
    s_sub_u32 s7, s7, 1
    s_cbranch_scc0 L_pl_165
    s_branch L_pok_164
L_fs_166:
L_fl_168:
    s_sleep 1
    ds_read_b32 v8, v6 offset:240
    s_waitcnt lgkmcnt(0)
    v_cmp_gt_u32 vcc, 3, v8
    s_cbranch_vccnz L_fl_168
    s_branch L_fr_167
L_fs_169:
L_fl_171:
    s_sleep 1
    ds_read_b32 v8, v6 offset:244
    s_waitcnt lgkmcnt(0)
    v_cmp_gt_u32 vcc, 8, v8
    s_cbranch_vccnz L_fl_171
    s_branch L_fr_170
L_fs_172:
L_fl_174:
    s_sleep 1
    ds_read_b32 v8, v6 offset:240
    s_waitcnt lgkmcnt(0)
    v_cmp_gt_u32 vcc, 12, v8
    s_cbranch_vccnz L_fl_174
    s_branch L_fr_173
L_fs_175:
L_fl_177:
    s_sleep 1
    ds_read_b32 v8, v6 offset:244
    s_waitcnt lgkmcnt(0)
    v_cmp_gt_u32 vcc, 15, v8
    s_cbranch_vccnz L_fl_177
    s_branch L_fr_176
L_fs_178:
L_fl_180:
    s_sleep 1
    ds_read_b32 v8, v55 offset:240
    s_waitcnt lgkmcnt(0)
    v_cmp_gt_u32 vcc, 19, v8
    s_cbranch_vccnz L_fl_180
    s_branch L_fr_179
L_fs_181:
L_fl_183:
    s_sleep 1
    ds_read_b32 v8, v55 offset:240
    s_waitcnt lgkmcnt(0)
    v_cmp_gt_u32 vcc, 24, v8
    s_cbranch_vccnz L_fl_183
    s_branch L_fr_182
L_fs_184:
L_fl_186:
    s_sleep 1
    ds_read_b32 v8, v6 offset:116
    s_waitcnt lgkmcnt(0)
    v_cmp_gt_u32 vcc, 1, v8
    s_cbranch_vccnz L_fl_186
    s_branch L_fr_185
L_fs_187:
L_fl_189:
    s_sleep 1
    ds_read_b32 v8, v56 offset:128
    s_waitcnt lgkmcnt(0)
    v_cmp_gt_u32 vcc, 30, v8
    s_cbranch_vccnz L_fl_189
    s_branch L_fr_188
    .p2align 7
    .type ctab,@object
ctab:
    .long 0, 1, 2, 3, 4, 5, 6, 7, 8, 9, 10, 11, 12, 13, 14, 15, 16, 17, 18, 19, 20, 21, 22, 23, 24, 25, 26, 27, 28, 29, 30, 31
    .size ctab, 128
.section .rodata,"a"
.p2align 6
.amdhsa_kernel recurrent_scan__ssm_conv_h3__mixer_channel_mlp__prompt_kernel
  .amdhsa_next_free_vgpr 168
  .amdhsa_next_free_sgpr 102
  .amdhsa_accum_offset 168
  .amdhsa_group_segment_fixed_size 0
  .amdhsa_kernarg_size 112
  .amdhsa_user_sgpr_count 2
  .amdhsa_user_sgpr_kernarg_segment_ptr 1
  .amdhsa_system_sgpr_workgroup_id_x 1
  .amdhsa_float_denorm_mode_32 3
.end_amdhsa_kernel
```
